```python
import torch

def _softmax(x, axis=-1):
    return torch.softmax(x, dim=axis)
def _gelu(x):
    return torch.nn.functional.gelu(x, approximate="tanh")
def _silu(x):
    return torch.nn.functional.silu(x)
def _sigmoid(x):
    return torch.sigmoid(x)
def _layernorm(x, axis=-1, eps=1e-5):
    m = x.mean(dim=axis, keepdim=True)
    v = x.var(dim=axis, keepdim=True, unbiased=False)
    return (x - m) / torch.sqrt(v + eps)
def _scatter_add(tgt, idx, src, axis=0):
    return tgt.clone().index_add_(axis, idx, src)
def _segment_sum(src, seg, n):
    out = torch.zeros((n,) + src.shape[1:], dtype=src.dtype)
    return out.index_add_(0, seg, src)
def _pad(x, pw):
    flat = tuple(v for pair in reversed(pw) for v in pair)
    return torch.nn.functional.pad(x, flat)

kernel_name = 'interleave_layers__linear_attn_block__sliding_block__prompt'

def setup_inputs():

    _w = (lambda a: (lambda t: t.to(torch.bfloat16) if t.is_floating_point() else t)(torch.as_tensor(a)))
    def _A_setup():
        B, S, D = 1, 2048, 640
        return {
            "x": _w((lambda *s: torch.randn(*s, dtype=torch.bfloat16) * 0.05)(B, S, D)),
            "wqkv": _w((lambda *s: torch.randn(*s, dtype=torch.bfloat16) * 0.05)(D, 3 * D)),
            "wo": _w((lambda *s: torch.randn(*s, dtype=torch.bfloat16) * 0.05)(D, D)),
        }
    _A_in = _A_setup()

    def _B_setup():
        B, S, D = 1, 2048, 640
        return {
            "x": _w((lambda *s: torch.randn(*s, dtype=torch.bfloat16) * 0.05)(B, S, D)),
            "wqkv": _w((lambda *s: torch.randn(*s, dtype=torch.bfloat16) * 0.05)(D, 3 * D)),
            "wo": _w((lambda *s: torch.randn(*s, dtype=torch.bfloat16) * 0.1)(D, D)),
        }
    _B_in = _B_setup()

    return {
        "A_x": _A_in["x"],
        "A_wqkv": _A_in["wqkv"],
        "A_wo": _A_in["wo"],
        "B_x": _B_in["x"],
        "B_wqkv": _B_in["wqkv"],
        "B_wo": _B_in["wo"],
    }

def reference(A_x, A_wqkv, A_wo, B_x, B_wqkv, B_wo):
    def _A_ref(x, wqkv, wo):
        B, S, D = x.shape
        H = 32; Dh = D // H
        qkv = (lambda x, *d: x.permute(*d))((x @ wqkv).reshape(B, S, 3, H, Dh), 2, 0, 3, 1, 4)
        q, k, v = qkv[0], qkv[1], qkv[2]
        phi = lambda t: torch.where(t > 0, t + 1, torch.exp(t)) + 1e-6
        pq, pk = phi(q), phi(k)
        kv = torch.einsum("bhsd,bhse->bhde", pk, v)
        z = torch.einsum("bhsd->bhd", pk)
        num = torch.einsum("bhqd,bhde->bhqe", pq, kv)
        den = torch.einsum("bhqd,bhd->bhq", pq, z)[..., None] + 1e-6
        o = num / den
        return (lambda x, *d: x.permute(*d))(o, 0, 2, 1, 3).reshape(B, S, D) @ wo

    def _B_ref(x, wqkv, wo):
        B, S, D = x.shape
        H = 32; Dh = D // H; W = 256
        qkv = (lambda x, *d: x.permute(*d))((x @ wqkv).reshape(B, S, 3, H, Dh), 2, 0, 3, 1, 4)
        q, k, v = qkv[0], qkv[1], qkv[2]
        scores = torch.einsum("bhqd,bhkd->bhqk", q, k) * (Dh ** -0.5)
        idx = torch.arange(S)
        mask = (idx[:, None] - idx[None, :] >= 0) & (idx[:, None] - idx[None, :] < W)
        scores = torch.where(mask[None, None], scores, -1e9)
        p = _softmax(scores, axis=-1)
        o = torch.einsum("bhqk,bhkd->bhqd", p, v)
        return (lambda x, *d: x.permute(*d))(o, 0, 2, 1, 3).reshape(B, S, D) @ wo

    x = A_x
    x = x + _A_ref(_layernorm(x, axis=-1), A_wqkv, A_wo)
    x = x + _B_ref(_layernorm(x, axis=-1), B_wqkv, B_wo)
    x = x + _A_ref(_layernorm(x, axis=-1), A_wqkv, A_wo)
    x = x + _B_ref(_layernorm(x, axis=-1), B_wqkv, B_wo)
    return x
```

```asm
; @launch grid=(256,1,1) block=(512,1,1) lds=163840
.amdgcn_target "amdgcn-amd-amdhsa--gfx950"
.text
.globl interleave_layers__linear_attn_block__sliding_block__prompt_kernel
.p2align 8
.type interleave_layers__linear_attn_block__sliding_block__prompt_kernel,@function
interleave_layers__linear_attn_block__sliding_block__prompt_kernel:
    s_cmp_ge_u32 s2, 256
    s_cbranch_scc1 L_END
    s_load_dwordx16 s[64:79], s[0:1], 0
    s_load_dwordx2 s[80:81], s[0:1], 64
    s_getreg_b32 s49, hwreg(HW_REG_XCC_ID, 0, 4)
    s_and_b32 s36, s2, 7
    s_lshr_b32 s37, s2, 3
    v_lshrrev_b32 v3, 6, v0
    v_and_b32 v1, 63, v0
    v_readfirstlane_b32 s38, v3
    v_lshlrev_b32 v2, 4, v1
    s_mov_b32 s44, -1
    s_mov_b32 s45, 0
    s_mov_b32 s39, 0
    s_mov_b32 s40, 0
    s_mov_b32 s41, 0
    s_mov_b32 s42, 0
    s_sub_u32 s50, 7, s38
    s_sub_u32 s51, s38, 4
    s_cmp_lt_u32 s38, 4
    s_cselect_b32 s43, s50, s51
    s_add_u32 s97, s38, s36
    s_and_b32 s97, s97, 7
    s_mul_i32 s50, s37, 40
    v_add_u32 v10, 0, v1
    v_mul_u32_u24 v11, 21846, v10
    v_lshrrev_b32 v11, 16, v11
    v_mul_u32_u24 v12, 3, v11
    v_sub_u32 v12, v10, v12
    v_lshlrev_b32 v12, 4, v12
    v_and_b32 v13, 0x30, v11
    v_and_b32 v14, 3, v11
    v_lshlrev_b32 v14, 2, v14
    v_add_u32 v13, v13, v14
    v_bfe_u32 v14, v11, 2, 2
    v_add_u32 v13, v13, v14
    v_mul_u32_u24 v13, 3840, v13
    v_add_u32 v13, v13, v12
    v_add_u32 v4, s50, v13
    v_add_u32 v10, 64, v1
    v_mul_u32_u24 v11, 21846, v10
    v_lshrrev_b32 v11, 16, v11
    v_mul_u32_u24 v12, 3, v11
    v_sub_u32 v12, v10, v12
    v_lshlrev_b32 v12, 4, v12
    v_and_b32 v13, 0x30, v11
    v_and_b32 v14, 3, v11
    v_lshlrev_b32 v14, 2, v14
    v_add_u32 v13, v13, v14
    v_bfe_u32 v14, v11, 2, 2
    v_add_u32 v13, v13, v14
    v_mul_u32_u24 v13, 3840, v13
    v_add_u32 v13, v13, v12
    v_add_u32 v5, s50, v13
    v_add_u32 v10, 128, v1
    v_mul_u32_u24 v11, 21846, v10
    v_lshrrev_b32 v11, 16, v11
    v_mul_u32_u24 v12, 3, v11
    v_sub_u32 v12, v10, v12
    v_lshlrev_b32 v12, 4, v12
    v_and_b32 v13, 0x30, v11
    v_and_b32 v14, 3, v11
    v_lshlrev_b32 v14, 2, v14
    v_add_u32 v13, v13, v14
    v_bfe_u32 v14, v11, 2, 2
    v_add_u32 v13, v13, v14
    v_mul_u32_u24 v13, 3840, v13
    v_add_u32 v13, v13, v12
    v_add_u32 v6, s50, v13
    s_waitcnt lgkmcnt(0)
    s_mov_b32 s32, s78
    s_and_b32 s33, s79, 0xffff
    s_mov_b32 s34, 256
    s_mov_b32 s35, 0x20000
    s_mov_b32 s93, 0
    s_or_b32 s50, s2, s38
    s_cmp_lg_u32 s50, 0
    s_cbranch_scc1 NC_E_1
    s_memrealtime s[50:51]
    s_waitcnt lgkmcnt(0)
    s_mul_i32 s50, s50, 0x9E3779B1
    s_mul_i32 s51, s51, 0x85EBCA77
    s_xor_b32 s50, s50, s51
    s_lshr_b32 s51, s50, 15
    s_xor_b32 s50, s50, s51
    s_mul_i32 s50, s50, 0x2C1B3C6D
    s_andn2_b32 s50, s50, 0x7f
    s_or_b32 s93, s50, 0x40
    v_mov_b32 v10, s93
    v_lshlrev_b32 v11, 6, v1
    s_mov_b64 exec, 0xf
    buffer_store_dword v10, v11, s[32:35], 0 offen sc1
    s_mov_b64 exec, -1
NC_E_1:
    s_mov_b32 s8, s64
    s_and_b32 s9, s65, 0xffff
    s_mov_b32 s10, 2621440
    s_mov_b32 s11, 0x20000
    s_mov_b32 s4, s80
    s_and_b32 s5, s81, 0xffff
    s_mov_b32 s6, 268435456
    s_mov_b32 s7, 0x20000
    s_mov_b32 s12, s66
    s_and_b32 s13, s67, 0xffff
    s_mov_b32 s14, 2457600
    s_mov_b32 s15, 0x20000
    s_cmp_lg_u32 s38, 1
    s_cbranch_scc1 W_2
    s_mul_i32 s53, s36, 307200
    s_mov_b32 m0, 0
    s_add_u32 s54, s53, 1272
    buffer_load_dwordx4 v4, s[12:15], s54 offen lds
    s_mov_b32 m0, 1024
    s_add_u32 s54, s53, 1272
    buffer_load_dwordx4 v5, s[12:15], s54 offen lds
    s_mov_b32 m0, 2048
    s_add_u32 s54, s53, 1272
    buffer_load_dwordx4 v6, s[12:15], s54 offen lds
    s_mov_b32 m0, 3072
    s_add_u32 s54, s53, 247032
    s_mov_b32 exec_hi, 0xffff
    buffer_load_dwordx4 v4, s[12:15], s54 offen lds
    s_mov_b64 exec, -1
    s_mov_b32 m0, 4096
    s_add_u32 s54, s53, 0
    buffer_load_dwordx4 v4, s[12:15], s54 offen lds
    s_mov_b32 m0, 5120
    s_add_u32 s54, s53, 0
    buffer_load_dwordx4 v5, s[12:15], s54 offen lds
    s_mov_b32 m0, 6144
    s_add_u32 s54, s53, 0
    buffer_load_dwordx4 v6, s[12:15], s54 offen lds
    s_mov_b32 m0, 7168
    s_add_u32 s54, s53, 245760
    s_mov_b32 exec_hi, 0xffff
    buffer_load_dwordx4 v4, s[12:15], s54 offen lds
    s_mov_b64 exec, -1
    s_mov_b32 m0, 8192
    s_add_u32 s54, s53, 2560
    buffer_load_dwordx4 v4, s[12:15], s54 offen lds
    s_mov_b32 m0, 9216
    s_add_u32 s54, s53, 2560
    buffer_load_dwordx4 v5, s[12:15], s54 offen lds
    s_mov_b32 m0, 10240
    s_add_u32 s54, s53, 2560
    buffer_load_dwordx4 v6, s[12:15], s54 offen lds
    s_mov_b32 m0, 11264
    s_add_u32 s54, s53, 248320
    s_mov_b32 exec_hi, 0xffff
    buffer_load_dwordx4 v4, s[12:15], s54 offen lds
    s_mov_b64 exec, -1
W_2:
    s_cmp_lg_u32 s38, 4
    s_cbranch_scc1 W_3
    s_lshl_b32 s52, s36, 3
    s_lshr_b32 s53, s37, 2
    s_add_u32 s52, s52, s53
    s_mul_i32 s52, s52, 41984
    s_and_b32 s53, s37, 3
    s_lshl_b32 s53, s53, 7
    s_add_u32 s52, s52, s53
    s_add_u32 s52, s52, 1048576
    v_lshlrev_b32 v30, 9, v1
    buffer_load_dword v31, v30, s[4:7], s52 offen
    s_add_u32 s52, s52, 32768
    s_mov_b64 exec, 0xffff
    buffer_load_dword v31, v30, s[4:7], s52 offen
    s_lshl_b32 s52, s36, 3
    s_lshr_b32 s53, s37, 2
    s_add_u32 s52, s52, s53
    s_lshl_b32 s52, s52, 11
    s_and_b32 s53, s37, 3
    s_lshl_b32 s53, s53, 7
    s_add_u32 s52, s52, s53
    s_add_u32 s52, s52, 33554432
    v_lshlrev_b32 v30, 9, v1
    s_mov_b64 exec, 0xf
    buffer_load_dword v31, v30, s[4:7], s52 offen
    s_mov_b64 exec, -1
W_3:
    s_cmp_lg_u32 s38, 7
    s_cbranch_scc1 W_4
    s_cmp_ge_u32 s37, 6
    s_cbranch_scc1 CPF_5
    s_getpc_b64 s[56:57]
L_PCREF:
    s_sub_u32 s56, s56, L_PCREF-interleave_layers__linear_attn_block__sliding_block__prompt_kernel
    s_subb_u32 s57, s57, 0
    s_lshl_b32 s53, s37, 13
    v_lshlrev_b32 v30, 7, v1
    v_add_u32 v30, s53, v30
    s_mov_b32 s58, L_CODE_END-interleave_layers__linear_attn_block__sliding_block__prompt_kernel-4
    v_min_u32 v30, s58, v30
    global_load_dword v31, v30, s[56:57]
CPF_5:
W_4:
    s_lshl_b32 s50, s36, 8
    s_lshl_b32 s51, s37, 3
    s_add_u32 s50, s50, s51
    s_mul_i32 s52, s50, 1280
    v_and_b32 v10, 7, v0
    v_lshrrev_b32 v11, 3, v0
    v_mul_u32_u24 v12, 1280, v10
    v_lshlrev_b32 v13, 4, v11
    v_add_u32 v12, v12, v13
    buffer_load_dwordx4 v[16:19], v12, s[8:11], s52 offen
    v_mov_b32 v20, 0
    v_mov_b32 v21, 0
    v_mov_b32 v22, 0
    v_mov_b32 v23, 0
    s_cmp_ge_u32 s38, 2
    s_cbranch_scc1 W_6
    buffer_load_dwordx4 v[20:23], v12, s[8:11], s52 offen offset:1024
W_6:
    s_mov_b32 s16, s68
    s_and_b32 s17, s69, 0xffff
    s_mov_b32 s18, 819200
    s_mov_b32 s19, 0x20000
    s_mov_b32 s20, s72
    s_and_b32 s21, s73, 0xffff
    s_mov_b32 s22, 2457600
    s_mov_b32 s23, 0x20000
    s_mov_b32 s24, s74
    s_and_b32 s25, s75, 0xffff
    s_mov_b32 s26, 819200
    s_mov_b32 s27, 0x20000
    s_mov_b32 s28, s76
    s_and_b32 s29, s77, 0xffff
    s_mov_b32 s30, 2621440
    s_mov_b32 s31, 0x20000
    s_cmp_lg_u32 s38, 0
    s_cbranch_scc1 W_7
    s_cmp_lg_u32 s2, 0
    s_cbranch_scc0 NON_DONE_9
NON_GET_8:
    s_mov_b32 s60, 0
    s_and_b32 s50, s37, 3
    s_lshl_b32 s50, s50, 6
    v_mov_b32 v11, s50
    s_waitcnt vmcnt(0)
NON_POLL_10:
    buffer_load_dword v12, v11, s[32:35], 0 offen sc1
    s_waitcnt vmcnt(0)
    v_readfirstlane_b32 s93, v12
    s_nop 3
    s_cmp_lg_u32 s93, 0
    s_cbranch_scc1 NON_DONE_9
    s_sleep 4
    s_add_u32 s60, s60, 1
    s_cmp_lt_u32 s60, 20000
    s_cbranch_scc1 NON_POLL_10
    s_mov_b32 s40, 1
NON_DONE_9:
    s_lshl_b32 s50, s36, 8
    s_lshl_b32 s51, s37, 2
    s_add_u32 s50, s50, s51
    s_add_u32 s50, s50, 8192
    s_and_b32 s51, s49, 7
    s_add_u32 s51, s51, s93
    s_add_u32 s51, s51, 8
    v_mov_b32 v10, s51
    v_mov_b32 v11, 0
    s_mov_b64 exec, 1
    buffer_store_dword v10, v11, s[4:7], s50 offen sc1
    s_mov_b64 exec, -1
    v_mov_b32 v10, s93
    v_mov_b32 v11, 61428
    ds_write_b32 v11, v10
W_7:
    s_lshl_b32 s53, s36, 3
    s_lshr_b32 s54, s37, 2
    s_add_u32 s53, s53, s54
    s_mul_i32 s53, s53, 41984
    s_and_b32 s54, s37, 3
    s_lshl_b32 s54, s54, 7
    s_add_u32 s53, s53, s54
    s_add_u32 s53, s53, 1048576
    v_and_b32 v10, 7, v0
    v_lshrrev_b32 v11, 3, v0
    v_lshrrev_b32 v13, 1, v11
    v_lshlrev_b32 v13, 10, v13
    v_and_b32 v14, 1, v11
    v_lshlrev_b32 v14, 9, v14
    v_add_u32 v13, v13, v14
    v_lshlrev_b32 v14, 4, v10
    v_add_u32 v13, v13, v14
    s_add_u32 s54, s53, 32768
    s_cmp_lg_u32 s38, 1
    s_cbranch_scc1 W_11
    v_mov_b32 v40, v13
    s_mov_b32 s94, s53
    v_bfe_u32 v10, v1, 4, 1
    v_lshlrev_b32 v10, 2, v10
    v_and_b32 v11, 3, v1
    v_add_u32 v10, v10, v11
    v_mov_b32 v106, 4096
    v_cmp_eq_u32 vcc, 1, v10
    v_mov_b32 v12, 4104
    s_nop 0
    v_cndmask_b32 v106, v106, v12, vcc
    v_cmp_eq_u32 vcc, 2, v10
    v_mov_b32 v12, 4112
    s_nop 0
    v_cndmask_b32 v106, v106, v12, vcc
    v_cmp_eq_u32 vcc, 3, v10
    v_mov_b32 v12, 4120
    s_nop 0
    v_cndmask_b32 v106, v106, v12, vcc
    v_cmp_eq_u32 vcc, 4, v10
    v_mov_b32 v12, 4128
    s_nop 0
    v_cndmask_b32 v106, v106, v12, vcc
    v_cmp_eq_u32 vcc, 5, v10
    v_mov_b32 v12, 4136
    s_nop 0
    v_cndmask_b32 v106, v106, v12, vcc
    v_cmp_eq_u32 vcc, 6, v10
    v_mov_b32 v12, 40
    s_nop 0
    v_cndmask_b32 v106, v106, v12, vcc
    v_cmp_eq_u32 vcc, 7, v10
    v_mov_b32 v12, 32
    s_nop 0
    v_cndmask_b32 v106, v106, v12, vcc
    v_mov_b32 v107, 8
    v_cmp_eq_u32 vcc, 1, v10
    v_mov_b32 v12, 16
    s_nop 0
    v_cndmask_b32 v107, v107, v12, vcc
    v_cmp_eq_u32 vcc, 2, v10
    v_mov_b32 v12, 8192
    s_nop 0
    v_cndmask_b32 v107, v107, v12, vcc
    v_cmp_eq_u32 vcc, 3, v10
    v_mov_b32 v12, 8200
    s_nop 0
    v_cndmask_b32 v107, v107, v12, vcc
    v_cmp_eq_u32 vcc, 4, v10
    v_mov_b32 v12, 8208
    s_nop 0
    v_cndmask_b32 v107, v107, v12, vcc
    v_cmp_eq_u32 vcc, 5, v10
    v_mov_b32 v12, 8216
    s_nop 0
    v_cndmask_b32 v107, v107, v12, vcc
    v_cmp_eq_u32 vcc, 6, v10
    v_mov_b32 v12, 24
    s_nop 0
    v_cndmask_b32 v107, v107, v12, vcc
    v_cmp_eq_u32 vcc, 7, v10
    v_mov_b32 v12, 8224
    s_nop 0
    v_cndmask_b32 v107, v107, v12, vcc
    v_bfe_u32 v11, v1, 2, 2
    v_mul_u32_u24 v11, 192, v11
    v_lshrrev_b32 v12, 5, v1
    v_mul_u32_u24 v12, 96, v12
    v_add_u32 v11, v11, v12
    v_add_u32 v106, v106, v11
    v_add_u32 v107, v107, v11
    s_waitcnt vmcnt(2)
    s_add_u32 s50, s37, 0
    s_mul_i32 s50, s50, 81920
    s_mul_i32 s51, s36, 10240
    s_add_u32 s50, s50, s51
    s_add_u32 s50, s50, 67108864
    ds_read_b64_tr_b16 v[48:49], v106 offset:0
    ds_read_b64_tr_b16 v[50:51], v106 offset:48
    ds_read_b64_tr_b16 v[52:53], v107 offset:0
    ds_read_b64_tr_b16 v[54:55], v107 offset:48
    ds_read_b64_tr_b16 v[56:57], v106 offset:768
    ds_read_b64_tr_b16 v[58:59], v106 offset:816
    ds_read_b64_tr_b16 v[60:61], v107 offset:768
    ds_read_b64_tr_b16 v[62:63], v107 offset:816
    ds_read_b64_tr_b16 v[64:65], v106 offset:1536
    ds_read_b64_tr_b16 v[66:67], v106 offset:1584
    ds_read_b64_tr_b16 v[68:69], v107 offset:1536
    ds_read_b64_tr_b16 v[70:71], v107 offset:1584
    ds_read_b64_tr_b16 v[72:73], v106 offset:2304
    ds_read_b64_tr_b16 v[74:75], v106 offset:2352
    ds_read_b64_tr_b16 v[76:77], v107 offset:2304
    ds_read_b64_tr_b16 v[78:79], v107 offset:2352
    ds_read_b64_tr_b16 v[80:81], v106 offset:3072
    ds_read_b64_tr_b16 v[82:83], v106 offset:3120
    ds_read_b64_tr_b16 v[84:85], v107 offset:3072
    ds_read_b64_tr_b16 v[86:87], v107 offset:3120
    s_mov_b32 s74, 0x00f00000
    s_mov_b32 s75, 0x00f00000
    v_mov_b32 v104, 0
    s_waitcnt lgkmcnt(0)
    v_cndmask_b32 v48, v48, v104, s[74:75]
    v_cndmask_b32 v49, v49, v104, s[74:75]
    v_cndmask_b32 v50, v50, v104, s[74:75]
    v_cndmask_b32 v51, v51, v104, s[74:75]
    v_cndmask_b32 v56, v56, v104, s[74:75]
    v_cndmask_b32 v57, v57, v104, s[74:75]
    v_cndmask_b32 v58, v58, v104, s[74:75]
    v_cndmask_b32 v59, v59, v104, s[74:75]
    v_cndmask_b32 v64, v64, v104, s[74:75]
    v_cndmask_b32 v65, v65, v104, s[74:75]
    v_cndmask_b32 v66, v66, v104, s[74:75]
    v_cndmask_b32 v67, v67, v104, s[74:75]
    v_cndmask_b32 v72, v72, v104, s[74:75]
    v_cndmask_b32 v73, v73, v104, s[74:75]
    v_cndmask_b32 v74, v74, v104, s[74:75]
    v_cndmask_b32 v75, v75, v104, s[74:75]
    v_cndmask_b32 v80, v80, v104, s[74:75]
    v_cndmask_b32 v81, v81, v104, s[74:75]
    v_cndmask_b32 v82, v82, v104, s[74:75]
    v_cndmask_b32 v83, v83, v104, s[74:75]
    buffer_store_dwordx4 v[48:51], v2, s[4:7], s50 offen sc1
    buffer_store_dwordx4 v[52:55], v2, s[4:7], s50 offen offset:1024 sc1
    s_add_u32 s50, s50, 2048
    buffer_store_dwordx4 v[56:59], v2, s[4:7], s50 offen sc1
    buffer_store_dwordx4 v[60:63], v2, s[4:7], s50 offen offset:1024 sc1
    s_add_u32 s50, s50, 2048
    buffer_store_dwordx4 v[64:67], v2, s[4:7], s50 offen sc1
    buffer_store_dwordx4 v[68:71], v2, s[4:7], s50 offen offset:1024 sc1
    s_add_u32 s50, s50, 2048
    buffer_store_dwordx4 v[72:75], v2, s[4:7], s50 offen sc1
    buffer_store_dwordx4 v[76:79], v2, s[4:7], s50 offen offset:1024 sc1
    s_add_u32 s50, s50, 2048
    buffer_store_dwordx4 v[80:83], v2, s[4:7], s50 offen sc1
    buffer_store_dwordx4 v[84:87], v2, s[4:7], s50 offen offset:1024 sc1
    s_add_u32 s50, s50, 2048
    v_mov_b32 v108, 0x3f803f80
    v_mov_b32 v109, 0x3f803f80
    v_mov_b32 v110, 0x3f803f80
    v_mov_b32 v111, 0x3f803f80
    s_nop 1
    v_mfma_f32_32x32x16_bf16 v[112:127], v[108:111], v[48:51], 0
    v_mfma_f32_32x32x16_bf16 v[128:143], v[108:111], v[52:55], 0
    v_mfma_f32_32x32x16_bf16 v[112:127], v[108:111], v[56:59], v[112:127]
    v_mfma_f32_32x32x16_bf16 v[128:143], v[108:111], v[60:63], v[128:143]
    v_mfma_f32_32x32x16_bf16 v[112:127], v[108:111], v[64:67], v[112:127]
    v_mfma_f32_32x32x16_bf16 v[128:143], v[108:111], v[68:71], v[128:143]
    v_mfma_f32_32x32x16_bf16 v[112:127], v[108:111], v[72:75], v[112:127]
    v_mfma_f32_32x32x16_bf16 v[128:143], v[108:111], v[76:79], v[128:143]
    v_mfma_f32_32x32x16_bf16 v[112:127], v[108:111], v[80:83], v[112:127]
    v_mfma_f32_32x32x16_bf16 v[128:143], v[108:111], v[84:87], v[128:143]
    s_nop 10
    v_mov_b32 v104, v112
    v_mov_b32 v105, v128
    s_add_u32 s50, s37, 0
    s_lshl_b32 s50, s50, 3
    s_add_u32 s50, s50, s36
    s_lshl_b32 s50, s50, 8
    s_add_u32 s50, s50, 75497472
    v_lshlrev_b32 v12, 3, v1
    s_mov_b64 exec, 0xffffffff
    buffer_store_dwordx2 v[104:105], v12, s[4:7], s50 offen sc1
    s_mov_b64 exec, -1
    v_mov_b32 v13, v40
    s_mov_b32 s53, s94
    s_add_u32 s54, s53, 32768
    s_waitcnt vmcnt(11)
W_11:
    s_cmp_eq_u32 s38, 1
    s_cbranch_scc1 P0_XW_12
    s_waitcnt vmcnt(0)
P0_XW_12:
    buffer_store_dwordx4 v[16:19], v13, s[4:7], s53 offen
    s_cmp_ge_u32 s38, 2
    s_cbranch_scc1 W_13
    buffer_store_dwordx4 v[20:23], v13, s[4:7], s54 offen
W_13:
    s_cmp_lg_u32 s38, 2
    s_cbranch_scc1 W_15
    s_mov_b32 s94, s53
    s_mov_b32 s95, s54
    s_mul_i32 s53, s36, 307200
    s_mov_b32 m0, 12288
    s_add_u32 s54, s53, 1272
    buffer_load_dwordx4 v4, s[20:23], s54 offen lds
    s_mov_b32 m0, 13312
    s_add_u32 s54, s53, 1272
    buffer_load_dwordx4 v5, s[20:23], s54 offen lds
    s_mov_b32 m0, 14336
    s_add_u32 s54, s53, 1272
    buffer_load_dwordx4 v6, s[20:23], s54 offen lds
    s_mov_b32 m0, 15360
    s_add_u32 s54, s53, 247032
    s_mov_b32 exec_hi, 0xffff
    buffer_load_dwordx4 v4, s[20:23], s54 offen lds
    s_mov_b64 exec, -1
    s_mov_b32 m0, 16384
    s_add_u32 s54, s53, 0
    buffer_load_dwordx4 v4, s[20:23], s54 offen lds
    s_mov_b32 m0, 17408
    s_add_u32 s54, s53, 0
    buffer_load_dwordx4 v5, s[20:23], s54 offen lds
    s_mov_b32 m0, 18432
    s_add_u32 s54, s53, 0
    buffer_load_dwordx4 v6, s[20:23], s54 offen lds
    s_mov_b32 m0, 19456
    s_add_u32 s54, s53, 245760
    s_mov_b32 exec_hi, 0xffff
    buffer_load_dwordx4 v4, s[20:23], s54 offen lds
    s_mov_b64 exec, -1
    s_mov_b32 m0, 20480
    s_add_u32 s54, s53, 2560
    buffer_load_dwordx4 v4, s[20:23], s54 offen lds
    s_mov_b32 m0, 21504
    s_add_u32 s54, s53, 2560
    buffer_load_dwordx4 v5, s[20:23], s54 offen lds
    s_mov_b32 m0, 22528
    s_add_u32 s54, s53, 2560
    buffer_load_dwordx4 v6, s[20:23], s54 offen lds
    s_mov_b32 m0, 23552
    s_add_u32 s54, s53, 248320
    s_mov_b32 exec_hi, 0xffff
    buffer_load_dwordx4 v4, s[20:23], s54 offen lds
    s_mov_b64 exec, -1
    s_mov_b32 s53, s94
    s_mov_b32 s54, s95
W_15:
    s_cmp_lg_u32 s38, 3
    s_cbranch_scc1 W_16
    v_add_u32 v15, 0, v1
    v_mul_u32_u24 v3, 6554, v15
    v_lshrrev_b32 v3, 16, v3
    v_mul_u32_u24 v24, 10, v3
    v_sub_u32 v24, v15, v24
    v_lshlrev_b32 v24, 4, v24
    v_mul_u32_u24 v3, 1280, v3
    v_add_u32 v24, v24, v3
    v_add_u32 v15, 64, v1
    v_mul_u32_u24 v3, 6554, v15
    v_lshrrev_b32 v3, 16, v3
    v_mul_u32_u24 v25, 10, v3
    v_sub_u32 v25, v15, v25
    v_lshlrev_b32 v25, 4, v25
    v_mul_u32_u24 v3, 1280, v3
    v_add_u32 v25, v25, v3
    v_add_u32 v15, 128, v1
    v_mul_u32_u24 v3, 6554, v15
    v_lshrrev_b32 v3, 16, v3
    v_mul_u32_u24 v26, 10, v3
    v_sub_u32 v26, v15, v26
    v_lshlrev_b32 v26, 4, v26
    v_mul_u32_u24 v3, 1280, v3
    v_add_u32 v26, v26, v3
    v_add_u32 v15, 192, v1
    v_mul_u32_u24 v3, 6554, v15
    v_lshrrev_b32 v3, 16, v3
    v_mul_u32_u24 v27, 10, v3
    v_sub_u32 v27, v15, v27
    v_lshlrev_b32 v27, 4, v27
    v_mul_u32_u24 v3, 1280, v3
    v_add_u32 v27, v27, v3
    v_add_u32 v15, 256, v1
    v_mul_u32_u24 v3, 6554, v15
    v_lshrrev_b32 v3, 16, v3
    v_mul_u32_u24 v28, 10, v3
    v_sub_u32 v28, v15, v28
    v_lshlrev_b32 v28, 4, v28
    v_mul_u32_u24 v3, 1280, v3
    v_add_u32 v28, v28, v3
    s_mov_b32 s58, s2
    s_mul_hi_u32 s55, s58, 0xccccccd
    s_mul_i32 s56, s55, 20
    s_sub_u32 s56, s58, s56
    s_and_b32 s57, s55, 7
    s_mul_i32 s57, s57, 160
    s_mul_i32 s56, s56, 40960
    s_add_u32 s56, s56, s57
    s_cmp_lt_u32 s55, 8
    s_cbranch_scc1 WOI_A_17
    s_mov_b32 m0, 24576
    s_nop 0
    buffer_load_dwordx4 v24, s[24:27], s56 offen lds
    s_mov_b32 m0, 25600
    s_nop 0
    buffer_load_dwordx4 v25, s[24:27], s56 offen lds
    s_mov_b32 m0, 26624
    s_nop 0
    buffer_load_dwordx4 v26, s[24:27], s56 offen lds
    s_mov_b32 m0, 27648
    s_nop 0
    buffer_load_dwordx4 v27, s[24:27], s56 offen lds
    s_mov_b32 m0, 28672
    s_nop 0
    buffer_load_dwordx4 v28, s[24:27], s56 offen lds
    s_branch WOI_E_18
WOI_A_17:
    s_mov_b32 m0, 24576
    s_nop 0
    buffer_load_dwordx4 v24, s[16:19], s56 offen lds
    s_mov_b32 m0, 25600
    s_nop 0
    buffer_load_dwordx4 v25, s[16:19], s56 offen lds
    s_mov_b32 m0, 26624
    s_nop 0
    buffer_load_dwordx4 v26, s[16:19], s56 offen lds
    s_mov_b32 m0, 27648
    s_nop 0
    buffer_load_dwordx4 v27, s[16:19], s56 offen lds
    s_mov_b32 m0, 28672
    s_nop 0
    buffer_load_dwordx4 v28, s[16:19], s56 offen lds
WOI_E_18:
    s_cmp_ge_u32 s2, 64
    s_cbranch_scc1 P0_NOI2_19
    s_add_u32 s59, s2, 256
    s_mul_hi_u32 s55, s59, 0xccccccd
    s_mul_i32 s56, s55, 20
    s_sub_u32 s56, s59, s56
    s_and_b32 s57, s55, 7
    s_mul_i32 s57, s57, 160
    s_mul_i32 s56, s56, 40960
    s_add_u32 s56, s56, s57
    s_cmp_lt_u32 s55, 8
    s_cbranch_scc1 WOI_A_20
    s_mov_b32 m0, 29696
    s_nop 0
    buffer_load_dwordx4 v24, s[24:27], s56 offen lds
    s_mov_b32 m0, 30720
    s_nop 0
    buffer_load_dwordx4 v25, s[24:27], s56 offen lds
    s_mov_b32 m0, 31744
    s_nop 0
    buffer_load_dwordx4 v26, s[24:27], s56 offen lds
    s_mov_b32 m0, 32768
    s_nop 0
    buffer_load_dwordx4 v27, s[24:27], s56 offen lds
    s_mov_b32 m0, 33792
    s_nop 0
    buffer_load_dwordx4 v28, s[24:27], s56 offen lds
    s_branch WOI_E_21
WOI_A_20:
    s_mov_b32 m0, 29696
    s_nop 0
    buffer_load_dwordx4 v24, s[16:19], s56 offen lds
    s_mov_b32 m0, 30720
    s_nop 0
    buffer_load_dwordx4 v25, s[16:19], s56 offen lds
    s_mov_b32 m0, 31744
    s_nop 0
    buffer_load_dwordx4 v26, s[16:19], s56 offen lds
    s_mov_b32 m0, 32768
    s_nop 0
    buffer_load_dwordx4 v27, s[16:19], s56 offen lds
    s_mov_b32 m0, 33792
    s_nop 0
    buffer_load_dwordx4 v28, s[16:19], s56 offen lds
WOI_E_21:
P0_NOI2_19:
W_16:
    v_mov_b32 v34, 0
    v_mov_b32 v35, 0
    v_lshlrev_b32 v36, 16, v16
    v_and_b32 v37, 0xffff0000, v16
    v_add_f32 v34, v34, v36
    v_fmac_f32 v35, v36, v36
    v_add_f32 v34, v34, v37
    v_fmac_f32 v35, v37, v37
    v_lshlrev_b32 v36, 16, v17
    v_and_b32 v37, 0xffff0000, v17
    v_add_f32 v34, v34, v36
    v_fmac_f32 v35, v36, v36
    v_add_f32 v34, v34, v37
    v_fmac_f32 v35, v37, v37
    v_lshlrev_b32 v36, 16, v18
    v_and_b32 v37, 0xffff0000, v18
    v_add_f32 v34, v34, v36
    v_fmac_f32 v35, v36, v36
    v_add_f32 v34, v34, v37
    v_fmac_f32 v35, v37, v37
    v_lshlrev_b32 v36, 16, v19
    v_and_b32 v37, 0xffff0000, v19
    v_add_f32 v34, v34, v36
    v_fmac_f32 v35, v36, v36
    v_add_f32 v34, v34, v37
    v_fmac_f32 v35, v37, v37
    v_lshlrev_b32 v36, 16, v20
    v_and_b32 v37, 0xffff0000, v20
    v_add_f32 v34, v34, v36
    v_fmac_f32 v35, v36, v36
    v_add_f32 v34, v34, v37
    v_fmac_f32 v35, v37, v37
    v_lshlrev_b32 v36, 16, v21
    v_and_b32 v37, 0xffff0000, v21
    v_add_f32 v34, v34, v36
    v_fmac_f32 v35, v36, v36
    v_add_f32 v34, v34, v37
    v_fmac_f32 v35, v37, v37
    v_lshlrev_b32 v36, 16, v22
    v_and_b32 v37, 0xffff0000, v22
    v_add_f32 v34, v34, v36
    v_fmac_f32 v35, v36, v36
    v_add_f32 v34, v34, v37
    v_fmac_f32 v35, v37, v37
    v_lshlrev_b32 v36, 16, v23
    v_and_b32 v37, 0xffff0000, v23
    v_add_f32 v34, v34, v36
    v_fmac_f32 v35, v36, v36
    v_add_f32 v34, v34, v37
    v_fmac_f32 v35, v37, v37
    s_nop 0
    v_mov_b32_dpp v36, v34 row_ror:8 row_mask:0xf bank_mask:0xf
    v_add_f32 v34, v34, v36
    v_mov_b32 v36, v34
    s_nop 1
    v_permlane16_swap_b32 v34, v36
    v_add_f32 v34, v34, v36
    v_mov_b32 v36, v34
    s_nop 1
    v_permlane32_swap_b32 v34, v36
    v_add_f32 v34, v34, v36
    s_nop 0
    v_mov_b32_dpp v36, v35 row_ror:8 row_mask:0xf bank_mask:0xf
    v_add_f32 v35, v35, v36
    v_mov_b32 v36, v35
    s_nop 1
    v_permlane16_swap_b32 v35, v36
    v_add_f32 v35, v35, v36
    v_mov_b32 v36, v35
    s_nop 1
    v_permlane32_swap_b32 v35, v36
    v_add_f32 v35, v35, v36
    s_lshl_b32 s50, s38, 6
    v_lshlrev_b32 v36, 3, v1
    v_add_u32 v36, s50, v36
    s_mov_b64 exec, 0xff
    ds_write_b64 v36, v[34:35] offset:49152
    s_mov_b64 exec, -1
    v_mov_b32 v10, 0
    v_mov_b32 v11, 52224
    ds_write_b32 v11, v10
    ds_write_b32 v11, v10 offset:8
    ds_write_b32 v11, v10 offset:12
    v_lshlrev_b32 v11, 2, v1
    ds_write_b32 v11, v10 offset:50176
    s_waitcnt lgkmcnt(0)
    s_barrier
    v_mov_b32 v11, 61428
    ds_read_b32 v10, v11
    s_waitcnt lgkmcnt(0)
    v_readfirstlane_b32 s93, v10
    s_cmp_lg_u32 s38, 0
    s_cbranch_scc1 W_22
    v_lshrrev_b32 v10, 2, v1
    v_and_b32 v10, 7, v10
    v_lshlrev_b32 v11, 3, v10
    ds_read_b64 v[28:29], v11 offset:49152
    ds_read_b64 v[30:31], v11 offset:49216
    ds_read_b64 v[32:33], v11 offset:49280
    ds_read_b64 v[34:35], v11 offset:49344
    ds_read_b64 v[36:37], v11 offset:49408
    ds_read_b64 v[38:39], v11 offset:49472
    ds_read_b64 v[40:41], v11 offset:49536
    ds_read_b64 v[42:43], v11 offset:49600
    s_waitcnt lgkmcnt(0)
    v_add_f32 v28, v28, v30
    v_add_f32 v29, v29, v31
    v_add_f32 v28, v28, v32
    v_add_f32 v29, v29, v33
    v_add_f32 v28, v28, v34
    v_add_f32 v29, v29, v35
    v_add_f32 v28, v28, v36
    v_add_f32 v29, v29, v37
    v_add_f32 v28, v28, v38
    v_add_f32 v29, v29, v39
    v_add_f32 v28, v28, v40
    v_add_f32 v29, v29, v41
    v_add_f32 v28, v28, v42
    v_add_f32 v29, v29, v43
    v_and_b32 v12, 3, v1
    v_cmp_eq_u32 vcc, 0, v12
    v_mov_b32 v30, 0
    v_mov_b32 v31, 0
    v_cndmask_b32 v28, v30, v28, vcc
    v_cndmask_b32 v29, v30, v29, vcc
    s_lshl_b32 s50, s36, 3
    s_lshr_b32 s51, s37, 2
    s_add_u32 s50, s50, s51
    s_lshl_b32 s50, s50, 11
    s_and_b32 s51, s37, 3
    s_lshl_b32 s51, s51, 7
    s_add_u32 s50, s50, s51
    s_add_u32 s50, s50, 33554432
    v_lshlrev_b32 v12, 9, v12
    v_lshlrev_b32 v10, 4, v10
    v_add_u32 v12, v12, v10
    s_mov_b64 exec, 0xffffffff
    buffer_store_dwordx4 v[28:31], v12, s[4:7], s50 offen
    s_mov_b64 exec, -1
W_22:
    s_cmp_lg_u32 s38, 2
    s_cbranch_scc1 W_23
    s_waitcnt vmcnt(12)
W_23:
    s_cmp_lg_u32 s38, 3
    s_cbranch_scc1 W_24
    s_waitcnt vmcnt(5)
W_24:
    s_sub_u32 s50, s38, 2
    s_cmp_lt_u32 s50, 2
    s_cbranch_scc1 P0_W23_25
    s_waitcnt vmcnt(0)
P0_W23_25:
    s_cmp_lg_u32 s38, 1
    s_cbranch_scc1 W_26
    s_lshl_b32 s52, s2, 6
    s_add_u32 s52, s52, 16384
    s_add_u32 s52, s52, 20
    s_add_u32 s63, s93, 1
    v_mov_b32 v11, s63
    v_mov_b32 v12, 0
    s_mov_b64 exec, 1
    buffer_store_dword v11, v12, s[4:7], s52 offen sc1
    s_mov_b64 exec, -1
W_26:
    s_barrier
    s_add_u32 s41, s41, 1
    s_cmp_lg_u32 s38, 0
    s_cbranch_scc1 W_27
    s_mov_b32 s60, 0
    v_and_b32 v11, 31, v1
    v_lshlrev_b32 v11, 2, v11
    s_lshl_b32 s50, s36, 8
    s_add_u32 s50, s50, 8192
    s_add_u32 s63, s93, 8
HELLO_28:
    buffer_load_dword v12, v11, s[4:7], s50 offen sc1
    s_waitcnt vmcnt(0)
    v_subrev_u32 v12, s63, v12
    v_cmp_lt_u32 vcc, 7, v12
    s_nop 3
    s_cmp_eq_u64 vcc, 0
    s_cbranch_scc1 HELLOD_29
    s_add_u32 s60, s60, 1
    s_cmp_lt_u32 s60, 20000
    s_cbranch_scc1 HELLO_28
    s_mov_b32 s40, 1
HELLOD_29:
    s_and_b32 s51, s49, 7
    v_cmp_ne_u32 vcc, s51, v12
    s_nop 3
    s_cmp_lg_u64 vcc, 0
    s_cselect_b32 s39, 1, 0
    s_lshl_b32 s50, s36, 8
    s_add_u32 s50, s50, 0
    s_lshl_b32 s51, s37, 2
    s_add_u32 s51, s51, s50
    s_add_u32 s62, s41, s93
    v_mov_b32 v10, s62
    v_mov_b32 v11, 0
    s_cmp_lg_u32 s39, 0
    s_cbranch_scc1 LB_GEN_30
    s_mov_b64 exec, 1
    buffer_store_dword v10, v11, s[4:7], s51 offen
    s_mov_b64 exec, -1
    s_branch LB_ST_31
LB_GEN_30:
    buffer_wbl2 sc1
    s_waitcnt vmcnt(0)
    s_mov_b64 exec, 1
    buffer_store_dword v10, v11, s[4:7], s51 offen sc1
    s_mov_b64 exec, -1
LB_ST_31:
    v_mov_b32 v10, s39
    v_mov_b32 v11, 61424
    ds_write_b32 v11, v10
    s_waitcnt lgkmcnt(0)
W_27:
    s_cmp_lt_u32 s38, 1
    s_cbranch_scc1 W_32
    s_sub_u32 s50, s38, 2
    s_cmp_lt_u32 s50, 2
    s_cbranch_scc1 FS_23_33
W_32:
    s_lshl_b32 s54, s37, 3
    s_add_u32 s54, s54, s97
    s_lshl_b32 s52, s54, 6
    s_add_u32 s52, s52, 16384
    v_mov_b32 v11, 20
    s_mov_b32 s53, 1
    s_cmp_lg_u32 s40, 0
    s_cbranch_scc1 POLLD_35
    s_mov_b32 s60, 0
    s_add_u32 s63, s93, s53
POLL_34:
    buffer_load_dword v12, v11, s[4:7], s52 offen sc1
    s_waitcnt vmcnt(0)
    v_subrev_u32 v12, s63, v12
    v_cmp_lt_u32 vcc, 7, v12
    s_nop 3
    s_and_b32 s61, vcc_lo, 0x1
    s_cmp_eq_u32 s61, 0
    s_cbranch_scc1 POLLD_35
    s_add_u32 s60, s60, 1
    s_cmp_lt_u32 s60, 20000
    s_cbranch_scc1 POLL_34
    s_mov_b32 s40, 1
POLLD_35:
    s_mul_i32 s50, s37, 81920
    s_mul_i32 s51, s97, 10240
    s_add_u32 s50, s50, s51
    s_add_u32 s50, s50, 67108864
    s_add_u32 s51, s51, 81920
    s_add_u32 m0, s51, 0
    s_add_u32 s52, s50, 0
    buffer_load_dwordx4 v2, s[4:7], s52 offen sc1 lds
    s_add_u32 m0, s51, 1024
    s_add_u32 s52, s50, 1024
    buffer_load_dwordx4 v2, s[4:7], s52 offen sc1 lds
    s_add_u32 m0, s51, 2048
    s_add_u32 s52, s50, 2048
    buffer_load_dwordx4 v2, s[4:7], s52 offen sc1 lds
    s_add_u32 m0, s51, 3072
    s_add_u32 s52, s50, 3072
    buffer_load_dwordx4 v2, s[4:7], s52 offen sc1 lds
    s_add_u32 m0, s51, 4096
    s_add_u32 s52, s50, 4096
    buffer_load_dwordx4 v2, s[4:7], s52 offen sc1 lds
    s_add_u32 m0, s51, 5120
    s_add_u32 s52, s50, 5120
    buffer_load_dwordx4 v2, s[4:7], s52 offen sc1 lds
    s_add_u32 m0, s51, 6144
    s_add_u32 s52, s50, 6144
    buffer_load_dwordx4 v2, s[4:7], s52 offen sc1 lds
    s_add_u32 m0, s51, 7168
    s_add_u32 s52, s50, 7168
    buffer_load_dwordx4 v2, s[4:7], s52 offen sc1 lds
    s_add_u32 m0, s51, 8192
    s_add_u32 s52, s50, 8192
    buffer_load_dwordx4 v2, s[4:7], s52 offen sc1 lds
    s_add_u32 m0, s51, 9216
    s_add_u32 s52, s50, 9216
    buffer_load_dwordx4 v2, s[4:7], s52 offen sc1 lds
    v_and_b32 v11, 31, v1
    v_lshlrev_b32 v11, 3, v11
    s_lshl_b32 s52, s37, 3
    s_add_u32 s52, s52, s97
    s_lshl_b32 s52, s52, 8
    s_add_u32 s52, s52, 75497472
    buffer_load_dwordx2 v[160:161], v11, s[4:7], s52 offen sc1
    s_branch FS_X_36
FS_23_33:
    s_lshl_b32 s54, s37, 3
    s_add_u32 s54, s54, s97
    s_lshl_b32 s52, s54, 6
    s_add_u32 s52, s52, 16384
    v_mov_b32 v11, 20
    s_mov_b32 s53, 1
    s_cmp_lg_u32 s40, 0
    s_cbranch_scc1 POLLD_38
    s_mov_b32 s60, 0
    s_add_u32 s63, s93, s53
POLL_37:
    buffer_load_dword v12, v11, s[4:7], s52 offen sc1
    s_waitcnt vmcnt(0)
    v_subrev_u32 v12, s63, v12
    v_cmp_lt_u32 vcc, 7, v12
    s_nop 3
    s_and_b32 s61, vcc_lo, 0x1
    s_cmp_eq_u32 s61, 0
    s_cbranch_scc1 POLLD_38
    s_add_u32 s60, s60, 1
    s_cmp_lt_u32 s60, 20000
    s_cbranch_scc1 POLL_37
    s_mov_b32 s40, 1
POLLD_38:
    s_mul_i32 s50, s37, 81920
    s_mul_i32 s51, s97, 10240
    s_add_u32 s50, s50, s51
    s_add_u32 s50, s50, 67108864
    s_add_u32 s51, s51, 81920
    s_add_u32 m0, s51, 0
    s_add_u32 s52, s50, 0
    buffer_load_dwordx4 v2, s[4:7], s52 offen sc1 lds
    s_add_u32 m0, s51, 1024
    s_add_u32 s52, s50, 1024
    buffer_load_dwordx4 v2, s[4:7], s52 offen sc1 lds
    s_add_u32 m0, s51, 2048
    s_add_u32 s52, s50, 2048
    buffer_load_dwordx4 v2, s[4:7], s52 offen sc1 lds
    s_add_u32 m0, s51, 3072
    s_add_u32 s52, s50, 3072
    buffer_load_dwordx4 v2, s[4:7], s52 offen sc1 lds
    s_add_u32 m0, s51, 4096
    s_add_u32 s52, s50, 4096
    buffer_load_dwordx4 v2, s[4:7], s52 offen sc1 lds
    s_add_u32 m0, s51, 5120
    s_add_u32 s52, s50, 5120
    buffer_load_dwordx4 v2, s[4:7], s52 offen sc1 lds
    s_add_u32 m0, s51, 6144
    s_add_u32 s52, s50, 6144
    buffer_load_dwordx4 v2, s[4:7], s52 offen sc1 lds
    s_add_u32 m0, s51, 7168
    s_add_u32 s52, s50, 7168
    buffer_load_dwordx4 v2, s[4:7], s52 offen sc1 lds
    s_add_u32 m0, s51, 8192
    s_add_u32 s52, s50, 8192
    buffer_load_dwordx4 v2, s[4:7], s52 offen sc1 lds
    s_add_u32 m0, s51, 9216
    s_add_u32 s52, s50, 9216
    buffer_load_dwordx4 v2, s[4:7], s52 offen sc1 lds
    v_and_b32 v11, 31, v1
    v_lshlrev_b32 v11, 3, v11
    s_lshl_b32 s52, s37, 3
    s_add_u32 s52, s52, s97
    s_lshl_b32 s52, s52, 8
    s_add_u32 s52, s52, 75497472
    buffer_load_dwordx2 v[160:161], v11, s[4:7], s52 offen sc1
    s_waitcnt vmcnt(11)
    s_cmp_lg_u32 s38, 2
    s_cbranch_scc1 W_39
    v_bfe_u32 v10, v1, 4, 1
    v_lshlrev_b32 v10, 2, v10
    v_and_b32 v11, 3, v1
    v_add_u32 v10, v10, v11
    v_mov_b32 v106, 16384
    v_cmp_eq_u32 vcc, 1, v10
    v_mov_b32 v12, 16392
    s_nop 0
    v_cndmask_b32 v106, v106, v12, vcc
    v_cmp_eq_u32 vcc, 2, v10
    v_mov_b32 v12, 16400
    s_nop 0
    v_cndmask_b32 v106, v106, v12, vcc
    v_cmp_eq_u32 vcc, 3, v10
    v_mov_b32 v12, 16408
    s_nop 0
    v_cndmask_b32 v106, v106, v12, vcc
    v_cmp_eq_u32 vcc, 4, v10
    v_mov_b32 v12, 16416
    s_nop 0
    v_cndmask_b32 v106, v106, v12, vcc
    v_cmp_eq_u32 vcc, 5, v10
    v_mov_b32 v12, 16424
    s_nop 0
    v_cndmask_b32 v106, v106, v12, vcc
    v_cmp_eq_u32 vcc, 6, v10
    v_mov_b32 v12, 12328
    s_nop 0
    v_cndmask_b32 v106, v106, v12, vcc
    v_cmp_eq_u32 vcc, 7, v10
    v_mov_b32 v12, 12320
    s_nop 0
    v_cndmask_b32 v106, v106, v12, vcc
    v_mov_b32 v107, 12296
    v_cmp_eq_u32 vcc, 1, v10
    v_mov_b32 v12, 12304
    s_nop 0
    v_cndmask_b32 v107, v107, v12, vcc
    v_cmp_eq_u32 vcc, 2, v10
    v_mov_b32 v12, 20480
    s_nop 0
    v_cndmask_b32 v107, v107, v12, vcc
    v_cmp_eq_u32 vcc, 3, v10
    v_mov_b32 v12, 20488
    s_nop 0
    v_cndmask_b32 v107, v107, v12, vcc
    v_cmp_eq_u32 vcc, 4, v10
    v_mov_b32 v12, 20496
    s_nop 0
    v_cndmask_b32 v107, v107, v12, vcc
    v_cmp_eq_u32 vcc, 5, v10
    v_mov_b32 v12, 20504
    s_nop 0
    v_cndmask_b32 v107, v107, v12, vcc
    v_cmp_eq_u32 vcc, 6, v10
    v_mov_b32 v12, 12312
    s_nop 0
    v_cndmask_b32 v107, v107, v12, vcc
    v_cmp_eq_u32 vcc, 7, v10
    v_mov_b32 v12, 20512
    s_nop 0
    v_cndmask_b32 v107, v107, v12, vcc
    v_bfe_u32 v11, v1, 2, 2
    v_mul_u32_u24 v11, 192, v11
    v_lshrrev_b32 v12, 5, v1
    v_mul_u32_u24 v12, 96, v12
    v_add_u32 v11, v11, v12
    v_add_u32 v106, v106, v11
    v_add_u32 v107, v107, v11
    s_add_u32 s50, s37, 32
    s_mul_i32 s50, s50, 81920
    s_mul_i32 s51, s36, 10240
    s_add_u32 s50, s50, s51
    s_add_u32 s50, s50, 67108864
    ds_read_b64_tr_b16 v[16:17], v106 offset:0
    ds_read_b64_tr_b16 v[18:19], v106 offset:48
    ds_read_b64_tr_b16 v[20:21], v107 offset:0
    ds_read_b64_tr_b16 v[22:23], v107 offset:48
    ds_read_b64_tr_b16 v[24:25], v106 offset:768
    ds_read_b64_tr_b16 v[26:27], v106 offset:816
    ds_read_b64_tr_b16 v[28:29], v107 offset:768
    ds_read_b64_tr_b16 v[30:31], v107 offset:816
    ds_read_b64_tr_b16 v[32:33], v106 offset:1536
    ds_read_b64_tr_b16 v[34:35], v106 offset:1584
    ds_read_b64_tr_b16 v[36:37], v107 offset:1536
    ds_read_b64_tr_b16 v[38:39], v107 offset:1584
    ds_read_b64_tr_b16 v[40:41], v106 offset:2304
    ds_read_b64_tr_b16 v[42:43], v106 offset:2352
    ds_read_b64_tr_b16 v[44:45], v107 offset:2304
    ds_read_b64_tr_b16 v[46:47], v107 offset:2352
    ds_read_b64_tr_b16 v[48:49], v106 offset:3072
    ds_read_b64_tr_b16 v[50:51], v106 offset:3120
    ds_read_b64_tr_b16 v[52:53], v107 offset:3072
    ds_read_b64_tr_b16 v[54:55], v107 offset:3120
    s_mov_b32 s74, 0x00f00000
    s_mov_b32 s75, 0x00f00000
    v_mov_b32 v104, 0
    s_waitcnt lgkmcnt(0)
    v_cndmask_b32 v16, v16, v104, s[74:75]
    v_cndmask_b32 v17, v17, v104, s[74:75]
    v_cndmask_b32 v18, v18, v104, s[74:75]
    v_cndmask_b32 v19, v19, v104, s[74:75]
    v_cndmask_b32 v24, v24, v104, s[74:75]
    v_cndmask_b32 v25, v25, v104, s[74:75]
    v_cndmask_b32 v26, v26, v104, s[74:75]
    v_cndmask_b32 v27, v27, v104, s[74:75]
    v_cndmask_b32 v32, v32, v104, s[74:75]
    v_cndmask_b32 v33, v33, v104, s[74:75]
    v_cndmask_b32 v34, v34, v104, s[74:75]
    v_cndmask_b32 v35, v35, v104, s[74:75]
    v_cndmask_b32 v40, v40, v104, s[74:75]
    v_cndmask_b32 v41, v41, v104, s[74:75]
    v_cndmask_b32 v42, v42, v104, s[74:75]
    v_cndmask_b32 v43, v43, v104, s[74:75]
    v_cndmask_b32 v48, v48, v104, s[74:75]
    v_cndmask_b32 v49, v49, v104, s[74:75]
    v_cndmask_b32 v50, v50, v104, s[74:75]
    v_cndmask_b32 v51, v51, v104, s[74:75]
    buffer_store_dwordx4 v[16:19], v2, s[4:7], s50 offen sc1
    buffer_store_dwordx4 v[20:23], v2, s[4:7], s50 offen offset:1024 sc1
    s_add_u32 s50, s50, 2048
    buffer_store_dwordx4 v[24:27], v2, s[4:7], s50 offen sc1
    buffer_store_dwordx4 v[28:31], v2, s[4:7], s50 offen offset:1024 sc1
    s_add_u32 s50, s50, 2048
    buffer_store_dwordx4 v[32:35], v2, s[4:7], s50 offen sc1
    buffer_store_dwordx4 v[36:39], v2, s[4:7], s50 offen offset:1024 sc1
    s_add_u32 s50, s50, 2048
    buffer_store_dwordx4 v[40:43], v2, s[4:7], s50 offen sc1
    buffer_store_dwordx4 v[44:47], v2, s[4:7], s50 offen offset:1024 sc1
    s_add_u32 s50, s50, 2048
    buffer_store_dwordx4 v[48:51], v2, s[4:7], s50 offen sc1
    buffer_store_dwordx4 v[52:55], v2, s[4:7], s50 offen offset:1024 sc1
    s_add_u32 s50, s50, 2048
    v_mov_b32 v108, 0x3f803f80
    v_mov_b32 v109, 0x3f803f80
    v_mov_b32 v110, 0x3f803f80
    v_mov_b32 v111, 0x3f803f80
    s_nop 1
    v_mfma_f32_32x32x16_bf16 v[112:127], v[108:111], v[16:19], 0
    v_mfma_f32_32x32x16_bf16 v[128:143], v[108:111], v[20:23], 0
    v_mfma_f32_32x32x16_bf16 v[112:127], v[108:111], v[24:27], v[112:127]
    v_mfma_f32_32x32x16_bf16 v[128:143], v[108:111], v[28:31], v[128:143]
    v_mfma_f32_32x32x16_bf16 v[112:127], v[108:111], v[32:35], v[112:127]
    v_mfma_f32_32x32x16_bf16 v[128:143], v[108:111], v[36:39], v[128:143]
    v_mfma_f32_32x32x16_bf16 v[112:127], v[108:111], v[40:43], v[112:127]
    v_mfma_f32_32x32x16_bf16 v[128:143], v[108:111], v[44:47], v[128:143]
    v_mfma_f32_32x32x16_bf16 v[112:127], v[108:111], v[48:51], v[112:127]
    v_mfma_f32_32x32x16_bf16 v[128:143], v[108:111], v[52:55], v[128:143]
    s_nop 10
    v_mov_b32 v104, v112
    v_mov_b32 v105, v128
    s_add_u32 s50, s37, 32
    s_lshl_b32 s50, s50, 3
    s_add_u32 s50, s50, s36
    s_lshl_b32 s50, s50, 8
    s_add_u32 s50, s50, 75497472
    v_lshlrev_b32 v12, 3, v1
    s_mov_b64 exec, 0xffffffff
    buffer_store_dwordx2 v[104:105], v12, s[4:7], s50 offen sc1
    s_mov_b64 exec, -1
W_39:
    s_cmp_lg_u32 s38, 3
    s_cbranch_scc1 W_40
    v_bfe_u32 v30, v1, 5, 1
    v_lshlrev_b32 v30, 4, v30
    v_bfe_u32 v12, v1, 4, 1
    v_lshlrev_b32 v12, 2, v12
    v_add_u32 v30, v30, v12
    v_bfe_u32 v12, v1, 2, 2
    v_add_u32 v30, v30, v12
    v_mul_u32_u24 v30, 160, v30
    v_and_b32 v12, 3, v1
    v_lshlrev_b32 v12, 3, v12
    v_add_u32 v30, v30, v12
    s_mov_b32 s58, s2
    ds_read_b64_tr_b16 v[32:33], v30 offset:24576
    ds_read_b64_tr_b16 v[34:35], v30 offset:25856
    ds_read_b64_tr_b16 v[36:37], v30 offset:24608
    ds_read_b64_tr_b16 v[38:39], v30 offset:25888
    ds_read_b64_tr_b16 v[40:41], v30 offset:24640
    ds_read_b64_tr_b16 v[42:43], v30 offset:25920
    ds_read_b64_tr_b16 v[44:45], v30 offset:24672
    ds_read_b64_tr_b16 v[46:47], v30 offset:25952
    ds_read_b64_tr_b16 v[48:49], v30 offset:24704
    ds_read_b64_tr_b16 v[50:51], v30 offset:25984
    s_mul_i32 s55, s58, 5120
    s_add_u32 s55, s55, 76546048
    s_waitcnt lgkmcnt(0)
    buffer_store_dwordx4 v[32:35], v2, s[4:7], s55 offen offset:0 sc1
    buffer_store_dwordx4 v[36:39], v2, s[4:7], s55 offen offset:1024 sc1
    buffer_store_dwordx4 v[40:43], v2, s[4:7], s55 offen offset:2048 sc1
    buffer_store_dwordx4 v[44:47], v2, s[4:7], s55 offen offset:3072 sc1
    s_add_u32 s55, s55, 4096
    buffer_store_dwordx4 v[48:51], v2, s[4:7], s55 offen offset:0 sc1
    s_cmp_ge_u32 s2, 64
    s_cbranch_scc1 P0_NOI2B_41
    s_add_u32 s59, s2, 256
    ds_read_b64_tr_b16 v[32:33], v30 offset:29696
    ds_read_b64_tr_b16 v[34:35], v30 offset:30976
    ds_read_b64_tr_b16 v[36:37], v30 offset:29728
    ds_read_b64_tr_b16 v[38:39], v30 offset:31008
    ds_read_b64_tr_b16 v[40:41], v30 offset:29760
    ds_read_b64_tr_b16 v[42:43], v30 offset:31040
    ds_read_b64_tr_b16 v[44:45], v30 offset:29792
    ds_read_b64_tr_b16 v[46:47], v30 offset:31072
    ds_read_b64_tr_b16 v[48:49], v30 offset:29824
    ds_read_b64_tr_b16 v[50:51], v30 offset:31104
    s_mul_i32 s55, s59, 5120
    s_add_u32 s55, s55, 76546048
    s_waitcnt lgkmcnt(0)
    buffer_store_dwordx4 v[32:35], v2, s[4:7], s55 offen offset:0 sc1
    buffer_store_dwordx4 v[36:39], v2, s[4:7], s55 offen offset:1024 sc1
    buffer_store_dwordx4 v[40:43], v2, s[4:7], s55 offen offset:2048 sc1
    buffer_store_dwordx4 v[44:47], v2, s[4:7], s55 offen offset:3072 sc1
    s_add_u32 s55, s55, 4096
    buffer_store_dwordx4 v[48:51], v2, s[4:7], s55 offen offset:0 sc1
P0_NOI2B_41:
W_40:
FS_X_36:
    s_cmp_lg_u32 s38, 0
    s_cbranch_scc1 W_42
    s_lshl_b32 s50, s36, 8
    s_add_u32 s50, s50, 0
    v_and_b32 v11, 31, v1
    v_lshlrev_b32 v11, 2, v11
    s_cmp_lg_u32 s40, 0
    s_cbranch_scc1 POLLD_44
    s_mov_b32 s60, 0
    s_add_u32 s63, s93, s41
POLL_43:
    buffer_load_dword v12, v11, s[4:7], s50 offen sc1
    s_waitcnt vmcnt(0)
    v_subrev_u32 v12, s63, v12
    v_cmp_lt_u32 vcc, 7, v12
    s_nop 3
    s_and_b32 s61, vcc_lo, 0xffffffff
    s_cmp_eq_u32 s61, 0
    s_cbranch_scc1 POLLD_44
    s_add_u32 s60, s60, 1
    s_cmp_lt_u32 s60, 20000
    s_cbranch_scc1 POLL_43
    s_mov_b32 s40, 1
POLLD_44:
    s_cmp_eq_u32 s39, 0
    s_cbranch_scc1 LB_NOINV_45
    buffer_inv sc1
    s_waitcnt vmcnt(0)
LB_NOINV_45:
W_42:
    v_and_b32 v10, 31, v1
    s_lshl_b32 s50, s43, 5
    s_add_u32 s50, s50, 256
    v_add_u32 v10, s50, v10
    v_mul_u32_u24 v10, 48, v10
    v_lshrrev_b32 v11, 5, v1
    v_lshlrev_b32 v12, 4, v11
    v_add_u32 v120, v10, v12
    v_lshlrev_b32 v12, 3, v11
    v_sub_u32 v121, v10, v12
    v_add_u32 v121, 32, v121
    v_add_u32 v122, v10, v12
    v_add_u32 v122, 24576, v122
    v_mul_u32_u24 v12, 24600, v11
    v_add_u32 v123, v10, v12
    v_add_u32 v123, 8, v123
    v_mul_u32_u24 v12, 24576, v11
    v_add_u32 v124, v10, v12
    v_add_u32 v124, 40, v124
    v_mov_b32 v4, v120
    v_mov_b32 v5, v121
    v_mov_b32 v6, v122
    v_mov_b32 v7, v123
    v_mov_b32 v8, v124
    v_and_b32 v10, 31, v1
    s_lshl_b32 s50, s43, 5
    v_add_u32 v10, s50, v10
    v_mul_u32_u24 v10, 48, v10
    v_lshrrev_b32 v11, 5, v1
    v_lshlrev_b32 v12, 4, v11
    v_add_u32 v105, v10, v12
    v_add_u32 v106, 32, v10
    v_bfe_u32 v12, v1, 2, 2
    v_lshlrev_b32 v13, 2, v11
    v_add_u32 v12, v12, v13
    v_add_u32 v12, s50, v12
    v_mul_u32_u24 v12, 48, v12
    v_and_b32 v13, 3, v1
    v_lshlrev_b32 v14, 3, v13
    v_min_u32 v15, 1, v13
    v_lshlrev_b32 v15, 3, v15
    v_add_u32 v15, 32, v15
    v_bfe_u32 v13, v1, 4, 1
    v_cmp_eq_u32 vcc, 1, v13
    s_nop 1
    v_cndmask_b32 v14, v14, v15, vcc
    v_add_u32 v12, v12, v14
    v_add_u32 v107, 24576, v12
    v_mov_b32 v176, v105
    v_mov_b32 v177, v106
    v_mov_b32 v178, v107
    v_bfe_u32 v11, v1, 4, 1
    v_mul_u32_u24 v11, 21504, v11
    v_and_b32 v12, 15, v1
    v_lshlrev_b32 v12, 4, v12
    v_add_u32 v11, v11, v12
    v_lshrrev_b32 v12, 5, v1
    s_mul_i32 s51, s37, 5
    v_add_u32 v12, s51, v12
    v_lshrrev_b32 v14, 3, v12
    v_lshlrev_b32 v40, 10, v14
    v_bfe_u32 v14, v12, 2, 1
    v_lshlrev_b32 v14, 9, v14
    v_add_u32 v40, v40, v14
    v_and_b32 v14, 1, v12
    v_lshlrev_b32 v14, 8, v14
    v_add_u32 v40, v40, v14
    v_bfe_u32 v14, v12, 1, 1
    v_lshlrev_b32 v14, 3, v14
    v_add_u32 v40, v40, v14
    v_add_u32 v40, v40, v11
    v_add_u32 v13, 2, v12
    v_lshrrev_b32 v14, 3, v13
    v_lshlrev_b32 v41, 10, v14
    v_bfe_u32 v14, v13, 2, 1
    v_lshlrev_b32 v14, 9, v14
    v_add_u32 v41, v41, v14
    v_and_b32 v14, 1, v13
    v_lshlrev_b32 v14, 8, v14
    v_add_u32 v41, v41, v14
    v_bfe_u32 v14, v13, 1, 1
    v_lshlrev_b32 v14, 3, v14
    v_add_u32 v41, v41, v14
    v_add_u32 v41, v41, v11
    s_add_u32 s51, s51, 4
    v_mov_b32 v13, s51
    v_lshrrev_b32 v14, 3, v13
    v_lshlrev_b32 v42, 10, v14
    v_bfe_u32 v14, v13, 2, 1
    v_lshlrev_b32 v14, 9, v14
    v_add_u32 v42, v42, v14
    v_and_b32 v14, 1, v13
    v_lshlrev_b32 v14, 8, v14
    v_add_u32 v42, v42, v14
    v_bfe_u32 v14, v13, 1, 1
    v_lshlrev_b32 v14, 3, v14
    v_add_u32 v42, v42, v14
    v_add_u32 v42, v42, v11
    v_mov_b32 v179, v40
    v_mov_b32 v180, v41
    v_mov_b32 v181, v42
    s_cmp_lg_u32 s38, 5
    s_cbranch_scc1 W_46
    v_and_b32 v10, 31, v1
    v_lshrrev_b32 v11, 5, v1
    v_lshlrev_b32 v13, 2, v11
    v_sub_u32 v10, v10, v13
    v_mov_b32 v14, 0xf149f2ca
    v_mov_b32 v15, 0
    v_cmp_le_i32 s[70:71], 0, v10
    v_cmp_le_i32 s[72:73], 1, v10
    v_cmp_le_i32 s[74:75], 2, v10
    v_cmp_le_i32 s[76:77], 3, v10
    v_cndmask_b32 v32, v14, v15, s[70:71]
    v_cndmask_b32 v33, v14, v15, s[72:73]
    v_cndmask_b32 v34, v14, v15, s[74:75]
    v_cndmask_b32 v35, v14, v15, s[76:77]
    v_cmp_le_i32 s[70:71], 8, v10
    v_cmp_le_i32 s[72:73], 9, v10
    v_cmp_le_i32 s[74:75], 10, v10
    v_cmp_le_i32 s[76:77], 11, v10
    v_cndmask_b32 v36, v14, v15, s[70:71]
    v_cndmask_b32 v37, v14, v15, s[72:73]
    v_cndmask_b32 v38, v14, v15, s[74:75]
    v_cndmask_b32 v39, v14, v15, s[76:77]
    v_cmp_le_i32 s[70:71], 16, v10
    v_cmp_le_i32 s[72:73], 17, v10
    v_cmp_le_i32 s[74:75], 18, v10
    v_cmp_le_i32 s[76:77], 19, v10
    v_cndmask_b32 v40, v14, v15, s[70:71]
    v_cndmask_b32 v41, v14, v15, s[72:73]
    v_cndmask_b32 v42, v14, v15, s[74:75]
    v_cndmask_b32 v43, v14, v15, s[76:77]
    v_cmp_le_i32 s[70:71], 24, v10
    v_cmp_le_i32 s[72:73], 25, v10
    v_cmp_le_i32 s[74:75], 26, v10
    v_cmp_le_i32 s[76:77], 27, v10
    v_cndmask_b32 v44, v14, v15, s[70:71]
    v_cndmask_b32 v45, v14, v15, s[72:73]
    v_cndmask_b32 v46, v14, v15, s[74:75]
    v_cndmask_b32 v47, v14, v15, s[76:77]
    ds_write_b128 v2, v[32:35] offset:55296
    ds_write_b128 v2, v[36:39] offset:56320
    ds_write_b128 v2, v[40:43] offset:57344
    ds_write_b128 v2, v[44:47] offset:58368
    s_waitcnt lgkmcnt(0)
W_46:
    s_waitcnt vmcnt(0)
    v_and_b32 v12, 31, v1
    v_lshlrev_b32 v12, 2, v12
    s_mov_b64 exec, 0xffffffff
    ds_add_f32 v12, v160 offset:50176
    ds_add_f32 v12, v161 offset:50304
    s_mov_b64 exec, -1
    s_mov_b32 s46, 1048576
    s_mov_b32 s90, 1048576
    s_mov_b32 s47, 16777216
    s_mov_b32 s48, 33554432
    s_mov_b32 s91, 33554432
    s_lshl_b32 s50, s36, 3
    s_add_u32 s50, s50, s43
    s_lshl_b32 s85, s50, 11
    s_add_u32 s85, s85, s48
    s_mul_i32 s84, s50, 41984
    s_add_u32 s84, s84, s46
    s_waitcnt lgkmcnt(0)
    s_barrier
    ds_read_b32 v188, v12 offset:50176
    ds_read_b32 v189, v12 offset:50304
    v_mov_b32 v11, 61424
    ds_read_b32 v10, v11
    s_waitcnt lgkmcnt(0)
    v_readfirstlane_b32 s39, v10
L_LAYER:
    s_mov_b32 s50, s84
    buffer_load_dwordx4 v[48:51], v2, s[4:7], s50 offen offset:0 sc1
    buffer_load_dwordx4 v[52:55], v2, s[4:7], s50 offen offset:1024 sc1
    buffer_load_dwordx4 v[56:59], v2, s[4:7], s50 offen offset:2048 sc1
    buffer_load_dwordx4 v[60:63], v2, s[4:7], s50 offen offset:3072 sc1
    v_add_u32 v3, 81920, v2
    v_add_u32 v15, 122880, v2
    ds_read_b128 v[80:83], v3 offset:0
    ds_read_b128 v[84:87], v3 offset:1024
    ds_read_b128 v[88:91], v3 offset:2048
    ds_read_b128 v[92:95], v3 offset:3072
    s_add_u32 s50, s50, 4096
    buffer_load_dwordx4 v[64:67], v2, s[4:7], s50 offen offset:0 sc1
    buffer_load_dwordx4 v[68:71], v2, s[4:7], s50 offen offset:1024 sc1
    buffer_load_dwordx4 v[72:75], v2, s[4:7], s50 offen offset:2048 sc1
    buffer_load_dwordx4 v[76:79], v2, s[4:7], s50 offen offset:3072 sc1
    s_mov_b32 s51, s85
    ds_read_b128 v[96:99], v3 offset:4096
    ds_read_b128 v[100:103], v3 offset:5120
    s_waitcnt vmcnt(7) lgkmcnt(4)
    v_mfma_f32_32x32x16_bf16 v[16:31], v[80:83], v[48:51], 0
    v_mfma_f32_32x32x16_bf16 v[32:47], v[84:87], v[48:51], 0
    s_add_u32 s50, s50, 4096
    buffer_load_dwordx4 v[48:51], v2, s[4:7], s50 offen offset:0 sc1
    ds_read_b128 v[80:83], v3 offset:6144
    ds_read_b128 v[84:87], v3 offset:7168
    s_waitcnt vmcnt(7) lgkmcnt(4)
    v_mfma_f32_32x32x16_bf16 v[16:31], v[88:91], v[52:55], v[16:31]
    v_mfma_f32_32x32x16_bf16 v[32:47], v[92:95], v[52:55], v[32:47]
    buffer_load_dwordx4 v[52:55], v2, s[4:7], s50 offen offset:1024 sc1
    ds_read_b128 v[88:91], v3 offset:8192
    ds_read_b128 v[92:95], v3 offset:9216
    s_waitcnt vmcnt(7) lgkmcnt(4)
    v_mfma_f32_32x32x16_bf16 v[16:31], v[96:99], v[56:59], v[16:31]
    v_mfma_f32_32x32x16_bf16 v[32:47], v[100:103], v[56:59], v[32:47]
    buffer_load_dwordx4 v[56:59], v2, s[4:7], s50 offen offset:2048 sc1
    ds_read_b128 v[96:99], v3 offset:10240
    ds_read_b128 v[100:103], v3 offset:11264
    s_waitcnt vmcnt(7) lgkmcnt(4)
    v_mfma_f32_32x32x16_bf16 v[16:31], v[80:83], v[60:63], v[16:31]
    v_mfma_f32_32x32x16_bf16 v[32:47], v[84:87], v[60:63], v[32:47]
    buffer_load_dwordx4 v[60:63], v2, s[4:7], s50 offen offset:3072 sc1
    ds_read_b128 v[80:83], v3 offset:12288
    ds_read_b128 v[84:87], v3 offset:13312
    s_waitcnt vmcnt(7) lgkmcnt(4)
    v_mfma_f32_32x32x16_bf16 v[16:31], v[88:91], v[64:67], v[16:31]
    v_mfma_f32_32x32x16_bf16 v[32:47], v[92:95], v[64:67], v[32:47]
    s_add_u32 s50, s50, 4096
    buffer_load_dwordx4 v[64:67], v2, s[4:7], s50 offen offset:0 sc1
    ds_read_b128 v[88:91], v3 offset:14336
    ds_read_b128 v[92:95], v3 offset:15360
    s_waitcnt vmcnt(7) lgkmcnt(4)
    v_mfma_f32_32x32x16_bf16 v[16:31], v[96:99], v[68:71], v[16:31]
    v_mfma_f32_32x32x16_bf16 v[32:47], v[100:103], v[68:71], v[32:47]
    buffer_load_dwordx4 v[68:71], v2, s[4:7], s50 offen offset:1024 sc1
    ds_read_b128 v[96:99], v3 offset:16384
    ds_read_b128 v[100:103], v3 offset:17408
    s_waitcnt vmcnt(7) lgkmcnt(4)
    v_mfma_f32_32x32x16_bf16 v[16:31], v[80:83], v[72:75], v[16:31]
    v_mfma_f32_32x32x16_bf16 v[32:47], v[84:87], v[72:75], v[32:47]
    buffer_load_dwordx4 v[72:75], v2, s[4:7], s50 offen offset:2048 sc1
    ds_read_b128 v[80:83], v3 offset:18432
    ds_read_b128 v[84:87], v3 offset:19456
    s_waitcnt vmcnt(7) lgkmcnt(4)
    v_mfma_f32_32x32x16_bf16 v[16:31], v[88:91], v[76:79], v[16:31]
    v_mfma_f32_32x32x16_bf16 v[32:47], v[92:95], v[76:79], v[32:47]
    buffer_load_dwordx4 v[76:79], v2, s[4:7], s50 offen offset:3072 sc1
    ds_read_b128 v[88:91], v3 offset:20480
    ds_read_b128 v[92:95], v3 offset:21504
    s_waitcnt vmcnt(7) lgkmcnt(4)
    v_mfma_f32_32x32x16_bf16 v[16:31], v[96:99], v[48:51], v[16:31]
    v_mfma_f32_32x32x16_bf16 v[32:47], v[100:103], v[48:51], v[32:47]
    s_add_u32 s50, s50, 4096
    buffer_load_dwordx4 v[48:51], v2, s[4:7], s50 offen offset:0 sc1
    ds_read_b128 v[96:99], v3 offset:22528
    ds_read_b128 v[100:103], v3 offset:23552
    s_waitcnt vmcnt(7) lgkmcnt(4)
    v_mfma_f32_32x32x16_bf16 v[16:31], v[80:83], v[52:55], v[16:31]
    v_mfma_f32_32x32x16_bf16 v[32:47], v[84:87], v[52:55], v[32:47]
    buffer_load_dwordx4 v[52:55], v2, s[4:7], s50 offen offset:1024 sc1
    ds_read_b128 v[80:83], v3 offset:24576
    ds_read_b128 v[84:87], v3 offset:25600
    s_waitcnt vmcnt(7) lgkmcnt(4)
    v_mfma_f32_32x32x16_bf16 v[16:31], v[88:91], v[56:59], v[16:31]
    v_mfma_f32_32x32x16_bf16 v[32:47], v[92:95], v[56:59], v[32:47]
    buffer_load_dwordx4 v[56:59], v2, s[4:7], s50 offen offset:2048 sc1
    s_cmp_lg_u32 s42, 0
    s_cbranch_scc1 QK_FL_47
    s_cmp_lg_u32 s38, 2
    s_cbranch_scc1 W_48
    s_lshl_b32 s54, s2, 6
    s_add_u32 s54, s54, 16384
    s_add_u32 s54, s54, 16
    s_add_u32 s63, s93, 1
    v_mov_b32 v13, s63
    v_mov_b32 v14, 0
    s_mov_b64 exec, 1
    buffer_store_dword v13, v14, s[4:7], s54 offen sc1
    s_mov_b64 exec, -1
W_48:
    s_cmp_lg_u32 s38, 3
    s_cbranch_scc1 W_49
    s_lshl_b32 s54, s2, 6
    s_add_u32 s54, s54, 16384
    s_add_u32 s54, s54, 24
    s_add_u32 s63, s93, 1
    v_mov_b32 v13, s63
    v_mov_b32 v14, 0
    s_mov_b64 exec, 1
    buffer_store_dword v13, v14, s[4:7], s54 offen sc1
    s_mov_b64 exec, -1
W_49:
QK_FL_47:
    ds_read_b128 v[88:91], v3 offset:26624
    ds_read_b128 v[92:95], v3 offset:27648
    s_waitcnt vmcnt(7) lgkmcnt(4)
    v_mfma_f32_32x32x16_bf16 v[16:31], v[96:99], v[60:63], v[16:31]
    v_mfma_f32_32x32x16_bf16 v[32:47], v[100:103], v[60:63], v[32:47]
    buffer_load_dwordx4 v[60:63], v2, s[4:7], s50 offen offset:3072 sc1
    ds_read_b128 v[96:99], v3 offset:28672
    ds_read_b128 v[100:103], v3 offset:29696
    s_waitcnt vmcnt(7) lgkmcnt(4)
    v_mfma_f32_32x32x16_bf16 v[16:31], v[80:83], v[64:67], v[16:31]
    v_mfma_f32_32x32x16_bf16 v[32:47], v[84:87], v[64:67], v[32:47]
    s_add_u32 s50, s50, 4096
    buffer_load_dwordx4 v[64:67], v2, s[4:7], s50 offen offset:0 sc1
    buffer_load_dwordx4 v[104:107], v2, s[4:7], s51 offen sc1
    ds_read_b128 v[80:83], v3 offset:30720
    ds_read_b128 v[84:87], v3 offset:31744
    s_waitcnt vmcnt(8) lgkmcnt(4)
    v_mfma_f32_32x32x16_bf16 v[16:31], v[88:91], v[68:71], v[16:31]
    v_mfma_f32_32x32x16_bf16 v[32:47], v[92:95], v[68:71], v[32:47]
    buffer_load_dwordx4 v[68:71], v2, s[4:7], s50 offen offset:1024 sc1
    ds_read_b128 v[88:91], v3 offset:32768
    ds_read_b128 v[92:95], v3 offset:33792
    s_waitcnt vmcnt(8) lgkmcnt(4)
    v_mfma_f32_32x32x16_bf16 v[16:31], v[96:99], v[72:75], v[16:31]
    v_mfma_f32_32x32x16_bf16 v[32:47], v[100:103], v[72:75], v[32:47]
    buffer_load_dwordx4 v[72:75], v2, s[4:7], s50 offen offset:2048 sc1
    buffer_load_dwordx4 v[108:111], v2, s[4:7], s51 offen offset:1024 sc1
    ds_read_b128 v[96:99], v3 offset:34816
    ds_read_b128 v[100:103], v3 offset:35840
    s_waitcnt vmcnt(9) lgkmcnt(4)
    v_mfma_f32_32x32x16_bf16 v[16:31], v[80:83], v[76:79], v[16:31]
    v_mfma_f32_32x32x16_bf16 v[32:47], v[84:87], v[76:79], v[32:47]
    buffer_load_dwordx4 v[76:79], v2, s[4:7], s50 offen offset:3072 sc1
    ds_read_b128 v[80:83], v3 offset:36864
    ds_read_b128 v[84:87], v3 offset:37888
    s_waitcnt vmcnt(9) lgkmcnt(4)
    v_mfma_f32_32x32x16_bf16 v[16:31], v[88:91], v[48:51], v[16:31]
    v_mfma_f32_32x32x16_bf16 v[32:47], v[92:95], v[48:51], v[32:47]
    s_add_u32 s50, s50, 4096
    buffer_load_dwordx4 v[48:51], v2, s[4:7], s50 offen offset:0 sc1
    s_cmp_lt_u32 s38, 4
    s_cbranch_scc1 W_50
    s_setprio 1
W_50:
    ds_read_b128 v[88:91], v3 offset:38912
    ds_read_b128 v[92:95], v3 offset:39936
    s_waitcnt vmcnt(9) lgkmcnt(4)
    v_mfma_f32_32x32x16_bf16 v[16:31], v[96:99], v[52:55], v[16:31]
    v_mfma_f32_32x32x16_bf16 v[32:47], v[100:103], v[52:55], v[32:47]
    buffer_load_dwordx4 v[52:55], v2, s[4:7], s50 offen offset:1024 sc1
    ds_read_b128 v[96:99], v15 offset:0
    ds_read_b128 v[100:103], v15 offset:1024
    s_waitcnt vmcnt(9) lgkmcnt(4)
    v_mfma_f32_32x32x16_bf16 v[16:31], v[80:83], v[56:59], v[16:31]
    v_mfma_f32_32x32x16_bf16 v[32:47], v[84:87], v[56:59], v[32:47]
    buffer_load_dwordx4 v[56:59], v2, s[4:7], s50 offen offset:2048 sc1
    ds_read_b128 v[80:83], v15 offset:2048
    ds_read_b128 v[84:87], v15 offset:3072
    s_waitcnt vmcnt(9) lgkmcnt(4)
    v_mfma_f32_32x32x16_bf16 v[16:31], v[88:91], v[60:63], v[16:31]
    v_mfma_f32_32x32x16_bf16 v[32:47], v[92:95], v[60:63], v[32:47]
    buffer_load_dwordx4 v[60:63], v2, s[4:7], s50 offen offset:3072 sc1
    ds_read_b128 v[88:91], v15 offset:4096
    ds_read_b128 v[92:95], v15 offset:5120
    s_waitcnt vmcnt(9) lgkmcnt(4)
    v_mfma_f32_32x32x16_bf16 v[16:31], v[96:99], v[64:67], v[16:31]
    v_mfma_f32_32x32x16_bf16 v[32:47], v[100:103], v[64:67], v[32:47]
    s_add_u32 s50, s50, 4096
    buffer_load_dwordx4 v[64:67], v2, s[4:7], s50 offen offset:0 sc1
    ds_read_b128 v[96:99], v15 offset:6144
    ds_read_b128 v[100:103], v15 offset:7168
    s_waitcnt vmcnt(8) lgkmcnt(4)
    v_mfma_f32_32x32x16_bf16 v[16:31], v[80:83], v[68:71], v[16:31]
    v_mfma_f32_32x32x16_bf16 v[32:47], v[84:87], v[68:71], v[32:47]
    buffer_load_dwordx4 v[68:71], v2, s[4:7], s50 offen offset:1024 sc1
    ds_read_b128 v[80:83], v15 offset:8192
    ds_read_b128 v[84:87], v15 offset:9216
    s_waitcnt vmcnt(8) lgkmcnt(4)
    v_mfma_f32_32x32x16_bf16 v[16:31], v[88:91], v[72:75], v[16:31]
    v_mfma_f32_32x32x16_bf16 v[32:47], v[92:95], v[72:75], v[32:47]
    buffer_load_dwordx4 v[72:75], v2, s[4:7], s50 offen offset:2048 sc1
    ds_read_b128 v[88:91], v15 offset:10240
    ds_read_b128 v[92:95], v15 offset:11264
    s_waitcnt vmcnt(7) lgkmcnt(4)
    v_mfma_f32_32x32x16_bf16 v[16:31], v[96:99], v[76:79], v[16:31]
    v_mfma_f32_32x32x16_bf16 v[32:47], v[100:103], v[76:79], v[32:47]
    buffer_load_dwordx4 v[76:79], v2, s[4:7], s50 offen offset:3072 sc1
    ds_read_b128 v[96:99], v15 offset:12288
    ds_read_b128 v[100:103], v15 offset:13312
    s_waitcnt vmcnt(7) lgkmcnt(4)
    v_mfma_f32_32x32x16_bf16 v[16:31], v[80:83], v[48:51], v[16:31]
    v_mfma_f32_32x32x16_bf16 v[32:47], v[84:87], v[48:51], v[32:47]
    s_add_u32 s50, s50, 4096
    buffer_load_dwordx4 v[48:51], v2, s[4:7], s50 offen offset:0 sc1
    ds_read_b128 v[80:83], v15 offset:14336
    ds_read_b128 v[84:87], v15 offset:15360
    s_waitcnt vmcnt(7) lgkmcnt(4)
    v_mfma_f32_32x32x16_bf16 v[16:31], v[88:91], v[52:55], v[16:31]
    v_mfma_f32_32x32x16_bf16 v[32:47], v[92:95], v[52:55], v[32:47]
    buffer_load_dwordx4 v[52:55], v2, s[4:7], s50 offen offset:1024 sc1
    s_bitcmp1_b32 s42, 0
    s_cselect_b64 s[70:71], -1, 0
    v_cndmask_b32 v116, v188, v190, s[70:71]
    v_cndmask_b32 v117, v189, v191, s[70:71]
    ds_read_b128 v[88:91], v15 offset:16384
    ds_read_b128 v[92:95], v15 offset:17408
    s_waitcnt vmcnt(7) lgkmcnt(4)
    v_mfma_f32_32x32x16_bf16 v[16:31], v[96:99], v[56:59], v[16:31]
    v_mfma_f32_32x32x16_bf16 v[32:47], v[100:103], v[56:59], v[32:47]
    buffer_load_dwordx4 v[56:59], v2, s[4:7], s50 offen offset:2048 sc1
    v_add_f32 v104, v104, v106
    v_add_f32 v105, v105, v107
    v_add_f32 v108, v108, v110
    v_add_f32 v109, v109, v111
    ds_read_b128 v[96:99], v15 offset:18432
    ds_read_b128 v[100:103], v15 offset:19456
    s_waitcnt vmcnt(7) lgkmcnt(4)
    v_mfma_f32_32x32x16_bf16 v[16:31], v[80:83], v[60:63], v[16:31]
    v_mfma_f32_32x32x16_bf16 v[32:47], v[84:87], v[60:63], v[32:47]
    buffer_load_dwordx4 v[60:63], v2, s[4:7], s50 offen offset:3072 sc1
    v_add_f32 v112, v104, v108
    v_add_f32 v113, v105, v109
    v_mov_b32 v114, v112
    v_mov_b32 v115, v113
    ds_read_b128 v[80:83], v15 offset:20480
    ds_read_b128 v[84:87], v15 offset:21504
    s_waitcnt vmcnt(7) lgkmcnt(4)
    v_mfma_f32_32x32x16_bf16 v[16:31], v[88:91], v[64:67], v[16:31]
    v_mfma_f32_32x32x16_bf16 v[32:47], v[92:95], v[64:67], v[32:47]
    s_add_u32 s50, s50, 4096
    buffer_load_dwordx4 v[64:67], v2, s[4:7], s50 offen offset:0 sc1
    v_mov_b32 v122, 0
    v_mov_b32 v123, 0
    v_permlane32_swap_b32 v112, v114
    v_permlane32_swap_b32 v113, v115
    ds_read_b128 v[88:91], v15 offset:22528
    ds_read_b128 v[92:95], v15 offset:23552
    s_waitcnt vmcnt(7) lgkmcnt(4)
    v_mfma_f32_32x32x16_bf16 v[16:31], v[96:99], v[68:71], v[16:31]
    v_mfma_f32_32x32x16_bf16 v[32:47], v[100:103], v[68:71], v[32:47]
    buffer_load_dwordx4 v[68:71], v2, s[4:7], s50 offen offset:1024 sc1
    v_add_f32 v112, v112, v114
    v_add_f32 v113, v113, v115
    s_mov_b32 s72, 0x3acccccd
    v_mul_f32 v112, s72, v112
    ds_read_b128 v[96:99], v15 offset:24576
    ds_read_b128 v[100:103], v15 offset:25600
    s_waitcnt vmcnt(7) lgkmcnt(4)
    v_mfma_f32_32x32x16_bf16 v[16:31], v[80:83], v[72:75], v[16:31]
    v_mfma_f32_32x32x16_bf16 v[32:47], v[84:87], v[72:75], v[32:47]
    buffer_load_dwordx4 v[72:75], v2, s[4:7], s50 offen offset:2048 sc1
    v_mul_f32 v113, s72, v113
    v_fma_f32 v113, -v112, v112, v113
    v_add_f32 v113, 0x3727c5ac, v113
    v_rsq_f32 v132, v113
    ds_read_b128 v[80:83], v15 offset:26624
    ds_read_b128 v[84:87], v15 offset:27648
    s_waitcnt vmcnt(7) lgkmcnt(4)
    v_mfma_f32_32x32x16_bf16 v[16:31], v[88:91], v[76:79], v[16:31]
    v_mfma_f32_32x32x16_bf16 v[32:47], v[92:95], v[76:79], v[32:47]
    buffer_load_dwordx4 v[76:79], v2, s[4:7], s50 offen offset:3072 sc1
    v_sub_f32 v114, 0, v112
    v_cvt_pk_bf16_f32 v120, v114, v114
    v_lshlrev_b32 v115, 16, v120
    v_sub_f32 v115, v114, v115
    ds_read_b128 v[88:91], v15 offset:28672
    ds_read_b128 v[92:95], v15 offset:29696
    s_waitcnt vmcnt(7) lgkmcnt(4)
    v_mfma_f32_32x32x16_bf16 v[16:31], v[96:99], v[48:51], v[16:31]
    v_mfma_f32_32x32x16_bf16 v[32:47], v[100:103], v[48:51], v[32:47]
    v_cvt_pk_bf16_f32 v121, v115, v122
    v_cndmask_b32 v120, v122, v120, s[44:45]
    v_cndmask_b32 v121, v122, v121, s[44:45]
    ds_read_b128 v[96:99], v15 offset:30720
    ds_read_b128 v[100:103], v15 offset:31744
    s_waitcnt vmcnt(6) lgkmcnt(4)
    v_mfma_f32_32x32x16_bf16 v[16:31], v[80:83], v[52:55], v[16:31]
    v_mfma_f32_32x32x16_bf16 v[32:47], v[84:87], v[52:55], v[32:47]
    v_cvt_pk_bf16_f32 v118, v116, v116
    v_lshlrev_b32 v118, 16, v118
    v_sub_f32 v119, v116, v118
    ds_read_b128 v[80:83], v15 offset:32768
    ds_read_b128 v[84:87], v15 offset:33792
    s_waitcnt vmcnt(5) lgkmcnt(4)
    v_mfma_f32_32x32x16_bf16 v[16:31], v[88:91], v[56:59], v[16:31]
    v_mfma_f32_32x32x16_bf16 v[32:47], v[92:95], v[56:59], v[32:47]
    v_cvt_pk_bf16_f32 v124, v118, v119
    v_cvt_pk_bf16_f32 v125, v118, v122
    v_cndmask_b32 v124, v122, v124, s[44:45]
    ds_read_b128 v[88:91], v15 offset:34816
    ds_read_b128 v[92:95], v15 offset:35840
    s_waitcnt vmcnt(4) lgkmcnt(4)
    v_mfma_f32_32x32x16_bf16 v[16:31], v[96:99], v[60:63], v[16:31]
    v_mfma_f32_32x32x16_bf16 v[32:47], v[100:103], v[60:63], v[32:47]
    v_cndmask_b32 v125, v122, v125, s[44:45]
    v_mov_b32 v126, 0
    v_mov_b32 v127, 0
    ds_read_b128 v[96:99], v15 offset:36864
    ds_read_b128 v[100:103], v15 offset:37888
    s_waitcnt vmcnt(3) lgkmcnt(4)
    v_mfma_f32_32x32x16_bf16 v[16:31], v[80:83], v[64:67], v[16:31]
    v_mfma_f32_32x32x16_bf16 v[32:47], v[84:87], v[64:67], v[32:47]
    v_cvt_pk_bf16_f32 v118, v117, v117
    v_lshlrev_b32 v118, 16, v118
    v_sub_f32 v119, v117, v118
    ds_read_b128 v[80:83], v15 offset:38912
    ds_read_b128 v[84:87], v15 offset:39936
    s_waitcnt vmcnt(2) lgkmcnt(4)
    v_mfma_f32_32x32x16_bf16 v[16:31], v[88:91], v[68:71], v[16:31]
    v_mfma_f32_32x32x16_bf16 v[32:47], v[92:95], v[68:71], v[32:47]
    v_cvt_pk_bf16_f32 v128, v118, v119
    v_cvt_pk_bf16_f32 v129, v118, v122
    v_cndmask_b32 v128, v122, v128, s[44:45]
    s_waitcnt vmcnt(1) lgkmcnt(2)
    v_mfma_f32_32x32x16_bf16 v[16:31], v[96:99], v[72:75], v[16:31]
    v_mfma_f32_32x32x16_bf16 v[32:47], v[100:103], v[72:75], v[32:47]
    v_cndmask_b32 v129, v122, v129, s[44:45]
    v_mov_b32 v130, 0
    v_mov_b32 v131, 0
    s_waitcnt vmcnt(0) lgkmcnt(0)
    v_mfma_f32_32x32x16_bf16 v[16:31], v[80:83], v[76:79], v[16:31]
    v_mfma_f32_32x32x16_bf16 v[32:47], v[84:87], v[76:79], v[32:47]
    s_setprio 0
    s_waitcnt vmcnt(0)
    v_mfma_f32_32x32x16_bf16 v[16:31], v[124:127], v[120:123], v[16:31]
    v_mfma_f32_32x32x16_bf16 v[32:47], v[128:131], v[120:123], v[32:47]
    v_mov_b32 v101, v132
    s_cmp_lg_u32 s42, 0
    s_nop 2
    s_cbranch_scc1 L0_CHK_51
    s_mul_i32 s62, s97, 10240
    s_add_u32 s62, s62, 81920
    v_add_u32 v13, s62, v2
    ds_read_b128 v[192:195], v13 offset:0
    ds_read_b128 v[196:199], v13 offset:1024
    ds_read_b128 v[200:203], v13 offset:2048
    ds_read_b128 v[204:207], v13 offset:3072
    ds_read_b128 v[208:211], v13 offset:4096
    ds_read_b128 v[212:215], v13 offset:5120
    ds_read_b128 v[216:219], v13 offset:6144
    ds_read_b128 v[220:223], v13 offset:7168
    ds_read_b128 v[224:227], v13 offset:8192
    ds_read_b128 v[228:231], v13 offset:9216
    s_cmp_lg_u32 s38, 0
    s_cbranch_scc1 W_52
    s_lshl_b32 s54, s37, 3
    s_lshl_b32 s52, s54, 6
    s_add_u32 s52, s52, 16384
    v_and_b32 v11, 7, v1
    v_lshlrev_b32 v11, 6, v11
    v_add_u32 v11, 16, v11
    s_mov_b32 s53, 1
    s_cmp_lg_u32 s40, 0
    s_cbranch_scc1 POLLD_54
    s_mov_b32 s60, 0
    s_add_u32 s63, s93, s53
POLL_53:
    buffer_load_dword v12, v11, s[4:7], s52 offen sc1
    s_waitcnt vmcnt(0)
    v_subrev_u32 v12, s63, v12
    v_cmp_lt_u32 vcc, 7, v12
    s_nop 3
    s_and_b32 s61, vcc_lo, 0xff
    s_cmp_eq_u32 s61, 0
    s_cbranch_scc1 POLLD_54
    s_add_u32 s60, s60, 1
    s_cmp_lt_u32 s60, 20000
    s_cbranch_scc1 POLL_53
    s_mov_b32 s40, 1
POLLD_54:
    s_and_b32 s50, s37, 7
    s_add_u32 s50, s50, 0
    s_mul_i32 s53, s50, 20
    v_min_u32 v11, 19, v1
    v_add_u32 v11, s53, v11
    v_and_b32 v11, 255, v11
    v_lshlrev_b32 v11, 6, v11
    s_mov_b32 s52, 16408
    s_mov_b32 s53, 1
    s_cmp_lg_u32 s40, 0
    s_cbranch_scc1 POLLD_56
    s_mov_b32 s60, 0
    s_add_u32 s63, s93, s53
POLL_55:
    buffer_load_dword v12, v11, s[4:7], s52 offen sc1
    s_waitcnt vmcnt(0)
    v_subrev_u32 v12, s63, v12
    v_cmp_lt_u32 vcc, 7, v12
    s_nop 3
    s_and_b32 s61, vcc_lo, 0xfffff
    s_cmp_eq_u32 s61, 0
    s_cbranch_scc1 POLLD_56
    s_add_u32 s60, s60, 1
    s_cmp_lt_u32 s60, 20000
    s_cbranch_scc1 POLL_55
    s_mov_b32 s40, 1
POLLD_56:
    s_and_b32 s50, s37, 7
    s_add_u32 s50, s50, 8
    s_mul_i32 s53, s50, 20
    v_min_u32 v11, 19, v1
    v_add_u32 v11, s53, v11
    v_and_b32 v11, 255, v11
    v_lshlrev_b32 v11, 6, v11
    s_mov_b32 s52, 16408
    s_mov_b32 s53, 1
    s_cmp_lg_u32 s40, 0
    s_cbranch_scc1 POLLD_58
    s_mov_b32 s60, 0
    s_add_u32 s63, s93, s53
POLL_57:
    buffer_load_dword v12, v11, s[4:7], s52 offen sc1
    s_waitcnt vmcnt(0)
    v_subrev_u32 v12, s63, v12
    v_cmp_lt_u32 vcc, 7, v12
    s_nop 3
    s_and_b32 s61, vcc_lo, 0xfffff
    s_cmp_eq_u32 s61, 0
    s_cbranch_scc1 POLLD_58
    s_add_u32 s60, s60, 1
    s_cmp_lt_u32 s60, 20000
    s_cbranch_scc1 POLL_57
    s_mov_b32 s40, 1
POLLD_58:
W_52:
L0_CHK_51:
L_AFTERQKV:
    s_bitcmp1_b32 s42, 0
    s_cbranch_scc1 L_BLAYER
    s_mov_b32 s53, 0x3fb8aa3b
    v_mul_f32 v102, s53, v101
    s_mov_b32 s52, 0x358637bd
    v_mul_f32 v106, v102, v28
    v_fma_f32 v107, v101, v28, s52
    v_exp_f32_e64 v106, v106 clamp
    v_max_f32 v107, s52, v107
    v_add_f32 v28, v106, v107
    v_mul_f32 v108, v102, v29
    v_fma_f32 v109, v101, v29, s52
    v_exp_f32_e64 v108, v108 clamp
    v_max_f32 v109, s52, v109
    v_add_f32 v29, v108, v109
    v_mul_f32 v110, v102, v30
    v_fma_f32 v111, v101, v30, s52
    v_exp_f32_e64 v110, v110 clamp
    v_max_f32 v111, s52, v111
    v_add_f32 v30, v110, v111
    v_mul_f32 v112, v102, v31
    v_fma_f32 v113, v101, v31, s52
    v_exp_f32_e64 v112, v112 clamp
    v_max_f32 v113, s52, v113
    v_add_f32 v31, v112, v113
    v_mul_f32 v106, v102, v32
    v_fma_f32 v107, v101, v32, s52
    v_exp_f32_e64 v106, v106 clamp
    v_max_f32 v107, s52, v107
    v_add_f32 v32, v106, v107
    v_mul_f32 v108, v102, v33
    v_fma_f32 v109, v101, v33, s52
    v_exp_f32_e64 v108, v108 clamp
    v_max_f32 v109, s52, v109
    v_add_f32 v33, v108, v109
    v_mul_f32 v110, v102, v34
    v_fma_f32 v111, v101, v34, s52
    v_exp_f32_e64 v110, v110 clamp
    v_max_f32 v111, s52, v111
    v_add_f32 v34, v110, v111
    v_mul_f32 v112, v102, v35
    v_fma_f32 v113, v101, v35, s52
    v_exp_f32_e64 v112, v112 clamp
    v_max_f32 v113, s52, v113
    v_add_f32 v35, v112, v113
    v_mul_f32 v36, v101, v36
    v_mul_f32 v37, v101, v37
    v_mul_f32 v38, v101, v38
    v_mul_f32 v39, v101, v39
    v_mul_f32 v40, v101, v40
    v_mul_f32 v41, v101, v41
    v_mul_f32 v42, v101, v42
    v_mul_f32 v43, v101, v43
    v_mul_f32 v106, v102, v44
    v_fma_f32 v107, v101, v44, s52
    v_exp_f32_e64 v106, v106 clamp
    v_max_f32 v107, s52, v107
    v_add_f32 v106, v106, v107
    v_mul_f32 v44, v101, v44
    v_cndmask_b32 v44, v44, v106, s[44:45]
    v_mul_f32 v108, v102, v45
    v_fma_f32 v109, v101, v45, s52
    v_exp_f32_e64 v108, v108 clamp
    v_max_f32 v109, s52, v109
    v_add_f32 v108, v108, v109
    v_mul_f32 v45, v101, v45
    v_cndmask_b32 v45, v45, v108, s[44:45]
    v_mul_f32 v110, v102, v46
    v_fma_f32 v111, v101, v46, s52
    v_exp_f32_e64 v110, v110 clamp
    v_max_f32 v111, s52, v111
    v_add_f32 v110, v110, v111
    v_mul_f32 v46, v101, v46
    v_cndmask_b32 v46, v46, v110, s[44:45]
    v_mul_f32 v112, v102, v47
    v_fma_f32 v113, v101, v47, s52
    v_exp_f32_e64 v112, v112 clamp
    v_max_f32 v113, s52, v113
    v_add_f32 v112, v112, v113
    v_mul_f32 v47, v101, v47
    v_cndmask_b32 v47, v47, v112, s[44:45]
    v_cvt_pk_bf16_f32 v126, v28, v29
    v_cvt_pk_bf16_f32 v127, v30, v31
    v_cvt_pk_bf16_f32 v128, v32, v33
    v_cvt_pk_bf16_f32 v129, v34, v35
    v_cvt_pk_bf16_f32 v130, v36, v37
    v_cvt_pk_bf16_f32 v131, v38, v39
    v_cvt_pk_bf16_f32 v132, v40, v41
    v_cvt_pk_bf16_f32 v133, v42, v43
    v_cvt_pk_bf16_f32 v134, v44, v45
    v_cvt_pk_bf16_f32 v135, v46, v47
    ds_write_b64 v4, v[128:129]
    ds_write_b64 v5, v[126:127]
    ds_write_b64 v6, v[130:131]
    ds_write_b64 v6, v[132:133] offset:16
    ds_write_b64 v7, v[134:135]
    v_mov_b32 v12, 0x3f80
    v_mov_b32 v13, 0
    v_cndmask_b32 v12, v12, v13, s[44:45]
    ds_write_b64 v8, v[12:13]
    s_waitcnt lgkmcnt(0)
    s_barrier
    s_cmp_lt_u32 s38, 4
    s_cbranch_scc1 W_59
    s_and_b32 s50, s37, 7
    s_add_u32 s50, s50, 0
    s_mul_i32 s50, s50, 102400
    s_sub_u32 s51, s38, 4
    s_mul_i32 s51, s51, 25600
    s_add_u32 s50, s50, s51
    s_add_u32 s50, s50, 76546048
    s_add_u32 s51, s51, 61440
    s_add_u32 m0, s51, 0
    s_add_u32 s52, s50, 0
    buffer_load_dwordx4 v2, s[4:7], s52 offen sc1 lds
    s_add_u32 m0, s51, 1024
    s_add_u32 s52, s50, 1024
    buffer_load_dwordx4 v2, s[4:7], s52 offen sc1 lds
    s_add_u32 m0, s51, 2048
    s_add_u32 s52, s50, 2048
    buffer_load_dwordx4 v2, s[4:7], s52 offen sc1 lds
    s_add_u32 m0, s51, 3072
    s_add_u32 s52, s50, 3072
    buffer_load_dwordx4 v2, s[4:7], s52 offen sc1 lds
    s_add_u32 m0, s51, 4096
    s_add_u32 s52, s50, 4096
    buffer_load_dwordx4 v2, s[4:7], s52 offen sc1 lds
    s_add_u32 m0, s51, 5120
    s_add_u32 s52, s50, 5120
    buffer_load_dwordx4 v2, s[4:7], s52 offen sc1 lds
    s_add_u32 m0, s51, 6144
    s_add_u32 s52, s50, 6144
    buffer_load_dwordx4 v2, s[4:7], s52 offen sc1 lds
    s_add_u32 m0, s51, 7168
    s_add_u32 s52, s50, 7168
    buffer_load_dwordx4 v2, s[4:7], s52 offen sc1 lds
    s_add_u32 m0, s51, 8192
    s_add_u32 s52, s50, 8192
    buffer_load_dwordx4 v2, s[4:7], s52 offen sc1 lds
    s_add_u32 m0, s51, 9216
    s_add_u32 s52, s50, 9216
    buffer_load_dwordx4 v2, s[4:7], s52 offen sc1 lds
    s_add_u32 m0, s51, 10240
    s_add_u32 s52, s50, 10240
    buffer_load_dwordx4 v2, s[4:7], s52 offen sc1 lds
    s_add_u32 m0, s51, 11264
    s_add_u32 s52, s50, 11264
    buffer_load_dwordx4 v2, s[4:7], s52 offen sc1 lds
    s_add_u32 m0, s51, 12288
    s_add_u32 s52, s50, 12288
    buffer_load_dwordx4 v2, s[4:7], s52 offen sc1 lds
    s_add_u32 m0, s51, 13312
    s_add_u32 s52, s50, 13312
    buffer_load_dwordx4 v2, s[4:7], s52 offen sc1 lds
    s_add_u32 m0, s51, 14336
    s_add_u32 s52, s50, 14336
    buffer_load_dwordx4 v2, s[4:7], s52 offen sc1 lds
    s_add_u32 m0, s51, 15360
    s_add_u32 s52, s50, 15360
    buffer_load_dwordx4 v2, s[4:7], s52 offen sc1 lds
    s_add_u32 m0, s51, 16384
    s_add_u32 s52, s50, 16384
    buffer_load_dwordx4 v2, s[4:7], s52 offen sc1 lds
    s_add_u32 m0, s51, 17408
    s_add_u32 s52, s50, 17408
    buffer_load_dwordx4 v2, s[4:7], s52 offen sc1 lds
    s_add_u32 m0, s51, 18432
    s_add_u32 s52, s50, 18432
    buffer_load_dwordx4 v2, s[4:7], s52 offen sc1 lds
    s_add_u32 m0, s51, 19456
    s_add_u32 s52, s50, 19456
    buffer_load_dwordx4 v2, s[4:7], s52 offen sc1 lds
    s_add_u32 m0, s51, 20480
    s_add_u32 s52, s50, 20480
    buffer_load_dwordx4 v2, s[4:7], s52 offen sc1 lds
    s_add_u32 m0, s51, 21504
    s_add_u32 s52, s50, 21504
    buffer_load_dwordx4 v2, s[4:7], s52 offen sc1 lds
    s_add_u32 m0, s51, 22528
    s_add_u32 s52, s50, 22528
    buffer_load_dwordx4 v2, s[4:7], s52 offen sc1 lds
    s_add_u32 m0, s51, 23552
    s_add_u32 s52, s50, 23552
    buffer_load_dwordx4 v2, s[4:7], s52 offen sc1 lds
    s_add_u32 m0, s51, 24576
    s_add_u32 s52, s50, 24576
    buffer_load_dwordx4 v2, s[4:7], s52 offen sc1 lds
W_59:
    s_cmp_lg_u32 s42, 0
    s_cbranch_scc1 LA_ST_60
    v_lshlrev_b32 v13, 7, v1
    s_cmp_lg_u32 s38, 6
    s_cbranch_scc1 W_61
    s_lshl_b32 s52, s36, 4
    s_lshr_b32 s53, s37, 1
    s_add_u32 s52, s52, s53
    s_mul_i32 s52, s52, 21504
    s_and_b32 s53, s37, 1
    s_mul_i32 s53, s53, 10240
    s_add_u32 s52, s52, s53
    s_add_u32 s52, s52, 16777216
    buffer_load_dword v182, v13, s[4:7], s52 offen
    s_add_u32 s52, s52, 8192
    s_mov_b64 exec, 0xffff
    buffer_load_dword v182, v13, s[4:7], s52 offen
    s_mov_b64 exec, -1
W_61:
    s_cmp_lt_u32 s38, 1
    s_cbranch_scc1 W_62
    s_add_u32 s50, s37, 32
    s_mul_i32 s50, s50, 81920
    s_mul_i32 s51, s97, 10240
    s_add_u32 s50, s50, s51
    s_add_u32 s50, s50, 67108864
    buffer_load_dwordx4 v[144:147], v2, s[4:7], s50 offen offset:0 sc1
    buffer_load_dwordx4 v[148:151], v2, s[4:7], s50 offen offset:1024 sc1
    buffer_load_dwordx4 v[152:155], v2, s[4:7], s50 offen offset:2048 sc1
    buffer_load_dwordx4 v[156:159], v2, s[4:7], s50 offen offset:3072 sc1
    s_add_u32 s50, s50, 4096
    buffer_load_dwordx4 v[232:235], v2, s[4:7], s50 offen offset:0 sc1
    buffer_load_dwordx4 v[236:239], v2, s[4:7], s50 offen offset:1024 sc1
    buffer_load_dwordx4 v[240:243], v2, s[4:7], s50 offen offset:2048 sc1
    buffer_load_dwordx4 v[244:247], v2, s[4:7], s50 offen offset:3072 sc1
    s_add_u32 s50, s50, 4096
    buffer_load_dwordx4 v[248:251], v2, s[4:7], s50 offen offset:0 sc1
    buffer_load_dwordx4 v[252:255], v2, s[4:7], s50 offen offset:1024 sc1
    v_and_b32 v11, 31, v1
    v_lshlrev_b32 v11, 3, v11
    s_add_u32 s52, s37, 32
    s_lshl_b32 s52, s52, 11
    s_add_u32 s52, s52, 75497472
    buffer_load_dwordx2 v[160:161], v11, s[4:7], s52 offen offset:0 sc1
    buffer_load_dwordx2 v[162:163], v11, s[4:7], s52 offen offset:256 sc1
    buffer_load_dwordx2 v[164:165], v11, s[4:7], s52 offen offset:512 sc1
    buffer_load_dwordx2 v[166:167], v11, s[4:7], s52 offen offset:768 sc1
    buffer_load_dwordx2 v[168:169], v11, s[4:7], s52 offen offset:1024 sc1
    buffer_load_dwordx2 v[170:171], v11, s[4:7], s52 offen offset:1280 sc1
    buffer_load_dwordx2 v[172:173], v11, s[4:7], s52 offen offset:1536 sc1
    buffer_load_dwordx2 v[174:175], v11, s[4:7], s52 offen offset:1792 sc1
W_62:
LA_ST_60:
    s_cmp_lt_u32 s38, 1
    s_cbranch_scc1 W_63
    s_mov_b32 s52, 0x358637bd
    v_mul_f32 v106, v102, v16
    v_fma_f32 v107, v101, v16, s52
    v_exp_f32_e64 v106, v106 clamp
    v_max_f32 v107, s52, v107
    v_add_f32 v16, v106, v107
    v_mul_f32 v108, v102, v17
    v_fma_f32 v109, v101, v17, s52
    v_exp_f32_e64 v108, v108 clamp
    v_max_f32 v109, s52, v109
    v_add_f32 v17, v108, v109
    v_mul_f32 v110, v102, v18
    v_fma_f32 v111, v101, v18, s52
    v_exp_f32_e64 v110, v110 clamp
    v_max_f32 v111, s52, v111
    v_add_f32 v18, v110, v111
    v_mul_f32 v106, v102, v19
    v_fma_f32 v107, v101, v19, s52
    v_exp_f32_e64 v106, v106 clamp
    v_max_f32 v107, s52, v107
    v_add_f32 v19, v106, v107
    v_mul_f32 v108, v102, v20
    v_fma_f32 v109, v101, v20, s52
    v_exp_f32_e64 v108, v108 clamp
    v_max_f32 v109, s52, v109
    v_add_f32 v20, v108, v109
    v_mul_f32 v110, v102, v21
    v_fma_f32 v111, v101, v21, s52
    v_exp_f32_e64 v110, v110 clamp
    v_max_f32 v111, s52, v111
    v_add_f32 v21, v110, v111
    v_mul_f32 v106, v102, v22
    v_fma_f32 v107, v101, v22, s52
    v_exp_f32_e64 v106, v106 clamp
    v_max_f32 v107, s52, v107
    v_add_f32 v22, v106, v107
    v_mul_f32 v108, v102, v23
    v_fma_f32 v109, v101, v23, s52
    v_exp_f32_e64 v108, v108 clamp
    v_max_f32 v109, s52, v109
    v_add_f32 v23, v108, v109
    v_mul_f32 v110, v102, v24
    v_fma_f32 v111, v101, v24, s52
    v_exp_f32_e64 v110, v110 clamp
    v_max_f32 v111, s52, v111
    v_add_f32 v24, v110, v111
    v_mul_f32 v106, v102, v25
    v_fma_f32 v107, v101, v25, s52
    v_exp_f32_e64 v106, v106 clamp
    v_max_f32 v107, s52, v107
    v_add_f32 v25, v106, v107
    v_mul_f32 v108, v102, v26
    v_fma_f32 v109, v101, v26, s52
    v_exp_f32_e64 v108, v108 clamp
    v_max_f32 v109, s52, v109
    v_add_f32 v26, v108, v109
    v_mul_f32 v110, v102, v27
    v_fma_f32 v111, v101, v27, s52
    v_exp_f32_e64 v110, v110 clamp
    v_max_f32 v111, s52, v111
    v_add_f32 v27, v110, v111
    v_cvt_pk_bf16_f32 v96, v16, v17
    v_cvt_pk_bf16_f32 v97, v18, v19
    v_cvt_pk_bf16_f32 v98, v20, v21
    v_cvt_pk_bf16_f32 v99, v22, v23
    v_cvt_pk_bf16_f32 v100, v24, v25
    v_cvt_pk_bf16_f32 v101, v26, v27
    v_mov_b32 v13, 0
    v_mov_b32 v102, 0
    v_mov_b32 v103, 0
    v_cndmask_b32 v100, v13, v100, s[44:45]
    v_cndmask_b32 v101, v13, v101, s[44:45]
W_63:
    s_cmp_lg_u32 s38, 0
    s_cbranch_scc1 W_64
    v_lshrrev_b32 v11, 5, v1
    v_bfe_u32 v12, v1, 2, 2
    v_lshlrev_b32 v13, 2, v11
    v_add_u32 v12, v12, v13
    v_add_u32 v12, 256, v12
    v_mul_u32_u24 v12, 48, v12
    v_and_b32 v13, 3, v1
    v_bfe_u32 v107, v1, 4, 1
    v_min_u32 v15, 1, v13
    v_lshlrev_b32 v15, 3, v15
    v_add_u32 v15, 32, v15
    v_lshlrev_b32 v14, 3, v13
    v_and_b32 v106, 1, v13
    v_lshlrev_b32 v106, 4, v106
    v_lshrrev_b32 v108, 1, v13
    v_lshlrev_b32 v108, 3, v108
    v_add_u32 v106, v106, v108
    v_cmp_eq_u32 vcc, 1, v107
    s_nop 1
    v_cndmask_b32 v14, v14, v15, vcc
    v_cndmask_b32 v106, v106, v15, vcc
    v_add_u32 v104, v12, v106
    v_add_u32 v105, v12, v14
    v_add_u32 v105, 24576, v105
    ds_read_b64_tr_b16 v[112:113], v104 offset:0
    ds_read_b64_tr_b16 v[114:115], v104 offset:384
    ds_read_b64_tr_b16 v[116:117], v105 offset:0
    ds_read_b64_tr_b16 v[118:119], v105 offset:384
    ds_read_b64_tr_b16 v[120:121], v104 offset:768
    ds_read_b64_tr_b16 v[122:123], v104 offset:1152
    ds_read_b64_tr_b16 v[124:125], v105 offset:768
    ds_read_b64_tr_b16 v[126:127], v105 offset:1152
    ds_read_b64_tr_b16 v[128:129], v104 offset:1536
    ds_read_b64_tr_b16 v[130:131], v104 offset:1920
    ds_read_b64_tr_b16 v[132:133], v105 offset:1536
    ds_read_b64_tr_b16 v[134:135], v105 offset:1920
    ds_read_b64_tr_b16 v[136:137], v104 offset:2304
    ds_read_b64_tr_b16 v[138:139], v104 offset:2688
    ds_read_b64_tr_b16 v[140:141], v105 offset:2304
    ds_read_b64_tr_b16 v[142:143], v105 offset:2688
    s_waitcnt lgkmcnt(12)
    v_mfma_f32_32x32x16_bf16 v[32:47], v[112:115], v[116:119], 0
    ds_read_b64_tr_b16 v[112:113], v104 offset:3072
    ds_read_b64_tr_b16 v[114:115], v104 offset:3456
    ds_read_b64_tr_b16 v[116:117], v105 offset:3072
    ds_read_b64_tr_b16 v[118:119], v105 offset:3456
    s_waitcnt lgkmcnt(12)
    v_mfma_f32_32x32x16_bf16 v[32:47], v[120:123], v[124:127], v[32:47]
    ds_read_b64_tr_b16 v[120:121], v104 offset:3840
    ds_read_b64_tr_b16 v[122:123], v104 offset:4224
    ds_read_b64_tr_b16 v[124:125], v105 offset:3840
    ds_read_b64_tr_b16 v[126:127], v105 offset:4224
    s_waitcnt lgkmcnt(12)
    v_mfma_f32_32x32x16_bf16 v[32:47], v[128:131], v[132:135], v[32:47]
    ds_read_b64_tr_b16 v[128:129], v104 offset:4608
    ds_read_b64_tr_b16 v[130:131], v104 offset:4992
    ds_read_b64_tr_b16 v[132:133], v105 offset:4608
    ds_read_b64_tr_b16 v[134:135], v105 offset:4992
    s_waitcnt lgkmcnt(12)
    v_mfma_f32_32x32x16_bf16 v[32:47], v[136:139], v[140:143], v[32:47]
    ds_read_b64_tr_b16 v[136:137], v104 offset:5376
    ds_read_b64_tr_b16 v[138:139], v104 offset:5760
    ds_read_b64_tr_b16 v[140:141], v105 offset:5376
    ds_read_b64_tr_b16 v[142:143], v105 offset:5760
    s_waitcnt lgkmcnt(12)
    v_mfma_f32_32x32x16_bf16 v[32:47], v[112:115], v[116:119], v[32:47]
    ds_read_b64_tr_b16 v[112:113], v104 offset:6144
    ds_read_b64_tr_b16 v[114:115], v104 offset:6528
    ds_read_b64_tr_b16 v[116:117], v105 offset:6144
    ds_read_b64_tr_b16 v[118:119], v105 offset:6528
    s_waitcnt lgkmcnt(12)
    v_mfma_f32_32x32x16_bf16 v[32:47], v[120:123], v[124:127], v[32:47]
    ds_read_b64_tr_b16 v[120:121], v104 offset:6912
    ds_read_b64_tr_b16 v[122:123], v104 offset:7296
    ds_read_b64_tr_b16 v[124:125], v105 offset:6912
    ds_read_b64_tr_b16 v[126:127], v105 offset:7296
    s_waitcnt lgkmcnt(12)
    v_mfma_f32_32x32x16_bf16 v[32:47], v[128:131], v[132:135], v[32:47]
    ds_read_b64_tr_b16 v[128:129], v104 offset:7680
    ds_read_b64_tr_b16 v[130:131], v104 offset:8064
    ds_read_b64_tr_b16 v[132:133], v105 offset:7680
    ds_read_b64_tr_b16 v[134:135], v105 offset:8064
    s_waitcnt lgkmcnt(12)
    v_mfma_f32_32x32x16_bf16 v[32:47], v[136:139], v[140:143], v[32:47]
    ds_read_b64_tr_b16 v[136:137], v104 offset:8448
    ds_read_b64_tr_b16 v[138:139], v104 offset:8832
    ds_read_b64_tr_b16 v[140:141], v105 offset:8448
    ds_read_b64_tr_b16 v[142:143], v105 offset:8832
    s_waitcnt lgkmcnt(12)
    v_mfma_f32_32x32x16_bf16 v[32:47], v[112:115], v[116:119], v[32:47]
    ds_read_b64_tr_b16 v[112:113], v104 offset:9216
    ds_read_b64_tr_b16 v[114:115], v104 offset:9600
    ds_read_b64_tr_b16 v[116:117], v105 offset:9216
    ds_read_b64_tr_b16 v[118:119], v105 offset:9600
    s_waitcnt lgkmcnt(12)
    v_mfma_f32_32x32x16_bf16 v[32:47], v[120:123], v[124:127], v[32:47]
    ds_read_b64_tr_b16 v[120:121], v104 offset:9984
    ds_read_b64_tr_b16 v[122:123], v104 offset:10368
    ds_read_b64_tr_b16 v[124:125], v105 offset:9984
    ds_read_b64_tr_b16 v[126:127], v105 offset:10368
    s_waitcnt lgkmcnt(12)
    v_mfma_f32_32x32x16_bf16 v[32:47], v[128:131], v[132:135], v[32:47]
    ds_read_b64_tr_b16 v[128:129], v104 offset:10752
    ds_read_b64_tr_b16 v[130:131], v104 offset:11136
    ds_read_b64_tr_b16 v[132:133], v105 offset:10752
    ds_read_b64_tr_b16 v[134:135], v105 offset:11136
    s_waitcnt lgkmcnt(12)
    v_mfma_f32_32x32x16_bf16 v[32:47], v[136:139], v[140:143], v[32:47]
    ds_read_b64_tr_b16 v[136:137], v104 offset:11520
    ds_read_b64_tr_b16 v[138:139], v104 offset:11904
    ds_read_b64_tr_b16 v[140:141], v105 offset:11520
    ds_read_b64_tr_b16 v[142:143], v105 offset:11904
    s_waitcnt lgkmcnt(12)
    v_mfma_f32_32x32x16_bf16 v[32:47], v[112:115], v[116:119], v[32:47]
    s_waitcnt lgkmcnt(8)
    v_mfma_f32_32x32x16_bf16 v[32:47], v[120:123], v[124:127], v[32:47]
    s_waitcnt lgkmcnt(4)
    v_mfma_f32_32x32x16_bf16 v[32:47], v[128:131], v[132:135], v[32:47]
    s_waitcnt lgkmcnt(0)
    v_mfma_f32_32x32x16_bf16 v[32:47], v[136:139], v[140:143], v[32:47]
    s_lshr_b32 s50, s42, 1
    s_mul_i32 s50, s50, 1048576
    s_add_u32 s50, s50, 50331648
    s_lshl_b32 s51, s37, 15
    s_add_u32 s50, s50, s51
    s_lshl_b32 s51, s36, 12
    s_add_u32 s51, s51, s50
    s_add_u32 s53, s42, 17
    s_add_u32 s53, s53, s93
    s_nop 2
    v_cvt_pk_bf16_f32 v48, v32, v33
    v_cvt_pk_bf16_f32 v49, v34, v35
    v_mov_b32 v50, s53
    v_mov_b32 v51, s53
    v_cvt_pk_bf16_f32 v52, v36, v37
    v_cvt_pk_bf16_f32 v53, v38, v39
    v_mov_b32 v54, s53
    v_mov_b32 v55, s53
    v_cvt_pk_bf16_f32 v56, v40, v41
    v_cvt_pk_bf16_f32 v57, v42, v43
    v_mov_b32 v58, s53
    v_mov_b32 v59, s53
    buffer_store_dwordx4 v[48:51], v2, s[4:7], s51 offen offset:0 sc1
    buffer_store_dwordx4 v[52:55], v2, s[4:7], s51 offen offset:1024 sc1
    buffer_store_dwordx4 v[56:59], v2, s[4:7], s51 offen offset:2048 sc1
    s_mov_b32 s52, 0x358637bd
    v_mul_f32 v106, v102, v16
    v_fma_f32 v107, v101, v16, s52
    v_exp_f32_e64 v106, v106 clamp
    v_max_f32 v107, s52, v107
    v_add_f32 v16, v106, v107
    v_mul_f32 v108, v102, v17
    v_fma_f32 v109, v101, v17, s52
    v_exp_f32_e64 v108, v108 clamp
    v_max_f32 v109, s52, v109
    v_add_f32 v17, v108, v109
    v_mul_f32 v110, v102, v18
    v_fma_f32 v111, v101, v18, s52
    v_exp_f32_e64 v110, v110 clamp
    v_max_f32 v111, s52, v111
    v_add_f32 v18, v110, v111
    v_mul_f32 v106, v102, v19
    v_fma_f32 v107, v101, v19, s52
    v_exp_f32_e64 v106, v106 clamp
    v_max_f32 v107, s52, v107
    v_add_f32 v19, v106, v107
    v_mul_f32 v108, v102, v20
    v_fma_f32 v109, v101, v20, s52
    v_exp_f32_e64 v108, v108 clamp
    v_max_f32 v109, s52, v109
    v_add_f32 v20, v108, v109
    v_mul_f32 v110, v102, v21
    v_fma_f32 v111, v101, v21, s52
    v_exp_f32_e64 v110, v110 clamp
    v_max_f32 v111, s52, v111
    v_add_f32 v21, v110, v111
    v_mul_f32 v106, v102, v22
    v_fma_f32 v107, v101, v22, s52
    v_exp_f32_e64 v106, v106 clamp
    v_max_f32 v107, s52, v107
    v_add_f32 v22, v106, v107
    v_mul_f32 v108, v102, v23
    v_fma_f32 v109, v101, v23, s52
    v_exp_f32_e64 v108, v108 clamp
    v_max_f32 v109, s52, v109
    v_add_f32 v23, v108, v109
    v_mul_f32 v110, v102, v24
    v_fma_f32 v111, v101, v24, s52
    v_exp_f32_e64 v110, v110 clamp
    v_max_f32 v111, s52, v111
    v_add_f32 v24, v110, v111
    v_mul_f32 v106, v102, v25
    v_fma_f32 v107, v101, v25, s52
    v_exp_f32_e64 v106, v106 clamp
    v_max_f32 v107, s52, v107
    v_add_f32 v25, v106, v107
    v_mul_f32 v108, v102, v26
    v_fma_f32 v109, v101, v26, s52
    v_exp_f32_e64 v108, v108 clamp
    v_max_f32 v109, s52, v109
    v_add_f32 v26, v108, v109
    v_mul_f32 v110, v102, v27
    v_fma_f32 v111, v101, v27, s52
    v_exp_f32_e64 v110, v110 clamp
    v_max_f32 v111, s52, v111
    v_add_f32 v27, v110, v111
    v_cvt_pk_bf16_f32 v96, v16, v17
    v_cvt_pk_bf16_f32 v97, v18, v19
    v_cvt_pk_bf16_f32 v98, v20, v21
    v_cvt_pk_bf16_f32 v99, v22, v23
    v_cvt_pk_bf16_f32 v100, v24, v25
    v_cvt_pk_bf16_f32 v101, v26, v27
    v_mov_b32 v13, 0
    v_mov_b32 v102, 0
    v_mov_b32 v103, 0
    v_cndmask_b32 v100, v13, v100, s[44:45]
    v_cndmask_b32 v101, v13, v101, s[44:45]
    v_and_b32 v10, 7, v1
    v_lshlrev_b32 v10, 12, v10
    v_add_u32 v10, 2048, v10
    s_mov_b32 s60, 0
KV_PP_67:
    buffer_load_dwordx4 v[88:91], v10, s[4:7], s50 offen sc1
    s_waitcnt vmcnt(0)
    v_mov_b32 v92, s53
    v_bitop3_b32 v88, v90, v91, v92 bitop3:0x7e
    v_cmp_ne_u32 vcc, 0, v88
    s_nop 3
    s_and_b32 s61, vcc_lo, 0xff
    s_cmp_eq_u32 s61, 0
    s_cbranch_scc1 KV_PPD_68
    s_add_u32 s60, s60, 1
    s_cmp_lt_u32 s60, 20000
    s_cbranch_scc1 KV_PP_67
KV_PPD_68:
    s_mov_b32 s60, 0
KV_POLL_65:
    s_mov_b32 s54, s50
    buffer_load_dwordx4 v[16:19], v2, s[4:7], s54 offen offset:0 sc1
    buffer_load_dwordx4 v[20:23], v2, s[4:7], s54 offen offset:1024 sc1
    buffer_load_dwordx4 v[24:27], v2, s[4:7], s54 offen offset:2048 sc1
    s_add_u32 s54, s54, 4096
    buffer_load_dwordx4 v[28:31], v2, s[4:7], s54 offen offset:0 sc1
    buffer_load_dwordx4 v[32:35], v2, s[4:7], s54 offen offset:1024 sc1
    buffer_load_dwordx4 v[36:39], v2, s[4:7], s54 offen offset:2048 sc1
    s_add_u32 s54, s54, 4096
    buffer_load_dwordx4 v[40:43], v2, s[4:7], s54 offen offset:0 sc1
    buffer_load_dwordx4 v[44:47], v2, s[4:7], s54 offen offset:1024 sc1
    buffer_load_dwordx4 v[48:51], v2, s[4:7], s54 offen offset:2048 sc1
    s_add_u32 s54, s54, 4096
    buffer_load_dwordx4 v[52:55], v2, s[4:7], s54 offen offset:0 sc1
    buffer_load_dwordx4 v[56:59], v2, s[4:7], s54 offen offset:1024 sc1
    buffer_load_dwordx4 v[60:63], v2, s[4:7], s54 offen offset:2048 sc1
    s_add_u32 s54, s54, 4096
    buffer_load_dwordx4 v[64:67], v2, s[4:7], s54 offen offset:0 sc1
    buffer_load_dwordx4 v[68:71], v2, s[4:7], s54 offen offset:1024 sc1
    buffer_load_dwordx4 v[72:75], v2, s[4:7], s54 offen offset:2048 sc1
    s_add_u32 s54, s54, 4096
    buffer_load_dwordx4 v[76:79], v2, s[4:7], s54 offen offset:0 sc1
    buffer_load_dwordx4 v[80:83], v2, s[4:7], s54 offen offset:1024 sc1
    buffer_load_dwordx4 v[84:87], v2, s[4:7], s54 offen offset:2048 sc1
    s_add_u32 s54, s54, 4096
    buffer_load_dwordx4 v[104:107], v2, s[4:7], s54 offen offset:0 sc1
    buffer_load_dwordx4 v[108:111], v2, s[4:7], s54 offen offset:1024 sc1
    buffer_load_dwordx4 v[112:115], v2, s[4:7], s54 offen offset:2048 sc1
    s_add_u32 s54, s54, 4096
    buffer_load_dwordx4 v[116:119], v2, s[4:7], s54 offen offset:0 sc1
    buffer_load_dwordx4 v[120:123], v2, s[4:7], s54 offen offset:1024 sc1
    buffer_load_dwordx4 v[124:127], v2, s[4:7], s54 offen offset:2048 sc1
    v_mov_b32 v88, 0
    v_mov_b32 v89, s53
    s_waitcnt vmcnt(21)
    v_bitop3_b32 v90, v18, v19, v89 bitop3:0x7e
    v_bitop3_b32 v91, v22, v23, v89 bitop3:0x7e
    v_bitop3_b32 v92, v26, v27, v89 bitop3:0x7e
    v_or3_b32 v88, v88, v90, v91
    v_or_b32 v88, v88, v92
    s_waitcnt vmcnt(18)
    v_bitop3_b32 v90, v30, v31, v89 bitop3:0x7e
    v_bitop3_b32 v91, v34, v35, v89 bitop3:0x7e
    v_bitop3_b32 v92, v38, v39, v89 bitop3:0x7e
    v_or3_b32 v88, v88, v90, v91
    v_or_b32 v88, v88, v92
    s_waitcnt vmcnt(15)
    v_bitop3_b32 v90, v42, v43, v89 bitop3:0x7e
    v_bitop3_b32 v91, v46, v47, v89 bitop3:0x7e
    v_bitop3_b32 v92, v50, v51, v89 bitop3:0x7e
    v_or3_b32 v88, v88, v90, v91
    v_or_b32 v88, v88, v92
    s_waitcnt vmcnt(12)
    v_bitop3_b32 v90, v54, v55, v89 bitop3:0x7e
    v_bitop3_b32 v91, v58, v59, v89 bitop3:0x7e
    v_bitop3_b32 v92, v62, v63, v89 bitop3:0x7e
    v_or3_b32 v88, v88, v90, v91
    v_or_b32 v88, v88, v92
    s_waitcnt vmcnt(9)
    v_bitop3_b32 v90, v66, v67, v89 bitop3:0x7e
    v_bitop3_b32 v91, v70, v71, v89 bitop3:0x7e
    v_bitop3_b32 v92, v74, v75, v89 bitop3:0x7e
    v_or3_b32 v88, v88, v90, v91
    v_or_b32 v88, v88, v92
    s_waitcnt vmcnt(6)
    v_bitop3_b32 v90, v78, v79, v89 bitop3:0x7e
    v_bitop3_b32 v91, v82, v83, v89 bitop3:0x7e
    v_bitop3_b32 v92, v86, v87, v89 bitop3:0x7e
    v_or3_b32 v88, v88, v90, v91
    v_or_b32 v88, v88, v92
    s_waitcnt vmcnt(3)
    v_bitop3_b32 v90, v106, v107, v89 bitop3:0x7e
    v_bitop3_b32 v91, v110, v111, v89 bitop3:0x7e
    v_bitop3_b32 v92, v114, v115, v89 bitop3:0x7e
    v_or3_b32 v88, v88, v90, v91
    v_or_b32 v88, v88, v92
    s_waitcnt vmcnt(0)
    v_bitop3_b32 v90, v118, v119, v89 bitop3:0x7e
    v_bitop3_b32 v91, v122, v123, v89 bitop3:0x7e
    v_bitop3_b32 v92, v126, v127, v89 bitop3:0x7e
    v_or3_b32 v88, v88, v90, v91
    v_or_b32 v88, v88, v92
    v_cmp_ne_u32 vcc, 0, v88
    s_nop 3
    s_cmp_eq_u64 vcc, 0
    s_cbranch_scc1 KV_DONE_66
    s_cmp_lg_u32 s40, 0
    s_cbranch_scc1 KV_DONE_66
    s_add_u32 s60, s60, 1
    s_cmp_lt_u32 s60, 20000
    s_cbranch_scc1 KV_POLL_65
    s_mov_b32 s40, 1
KV_DONE_66:
    s_add_u32 s59, s42, 1
    v_mov_b32 v11, 52224
    v_mov_b32 v12, s59
    ds_write_b32 v11, v12
    v_mov_b32 v88, 0x00003f80
    v_mov_b32 v89, 0x3f800000
    v_mov_b32 v128, 0
    v_mov_b32 v129, 0
    v_mov_b32 v130, 0
    v_mov_b32 v131, 0
    v_mov_b32 v132, 0
    v_mov_b32 v133, 0
    v_mov_b32 v134, 0
    v_mov_b32 v135, 0
    v_mov_b32 v136, 0
    v_mov_b32 v137, 0
    v_mov_b32 v138, 0
    v_mov_b32 v139, 0
    v_dot2c_f32_bf16 v128, v16, v88
    v_dot2c_f32_bf16 v129, v16, v89
    v_dot2c_f32_bf16 v130, v17, v88
    v_dot2c_f32_bf16 v131, v17, v89
    v_dot2c_f32_bf16 v132, v20, v88
    v_dot2c_f32_bf16 v133, v20, v89
    v_dot2c_f32_bf16 v134, v21, v88
    v_dot2c_f32_bf16 v135, v21, v89
    v_dot2c_f32_bf16 v136, v24, v88
    v_dot2c_f32_bf16 v137, v24, v89
    v_dot2c_f32_bf16 v138, v25, v88
    v_dot2c_f32_bf16 v139, v25, v89
    v_dot2c_f32_bf16 v128, v28, v88
    v_dot2c_f32_bf16 v129, v28, v89
    v_dot2c_f32_bf16 v130, v29, v88
    v_dot2c_f32_bf16 v131, v29, v89
    v_dot2c_f32_bf16 v132, v32, v88
    v_dot2c_f32_bf16 v133, v32, v89
    v_dot2c_f32_bf16 v134, v33, v88
    v_dot2c_f32_bf16 v135, v33, v89
    v_dot2c_f32_bf16 v136, v36, v88
    v_dot2c_f32_bf16 v137, v36, v89
    v_dot2c_f32_bf16 v138, v37, v88
    v_dot2c_f32_bf16 v139, v37, v89
    v_dot2c_f32_bf16 v128, v40, v88
    v_dot2c_f32_bf16 v129, v40, v89
    v_dot2c_f32_bf16 v130, v41, v88
    v_dot2c_f32_bf16 v131, v41, v89
    v_dot2c_f32_bf16 v132, v44, v88
    v_dot2c_f32_bf16 v133, v44, v89
    v_dot2c_f32_bf16 v134, v45, v88
    v_dot2c_f32_bf16 v135, v45, v89
    v_dot2c_f32_bf16 v136, v48, v88
    v_dot2c_f32_bf16 v137, v48, v89
    v_dot2c_f32_bf16 v138, v49, v88
    v_dot2c_f32_bf16 v139, v49, v89
    v_dot2c_f32_bf16 v128, v52, v88
    v_dot2c_f32_bf16 v129, v52, v89
    v_dot2c_f32_bf16 v130, v53, v88
    v_dot2c_f32_bf16 v131, v53, v89
    v_dot2c_f32_bf16 v132, v56, v88
    v_dot2c_f32_bf16 v133, v56, v89
    v_dot2c_f32_bf16 v134, v57, v88
    v_dot2c_f32_bf16 v135, v57, v89
    v_dot2c_f32_bf16 v136, v60, v88
    v_dot2c_f32_bf16 v137, v60, v89
    v_dot2c_f32_bf16 v138, v61, v88
    v_dot2c_f32_bf16 v139, v61, v89
    v_dot2c_f32_bf16 v128, v64, v88
    v_dot2c_f32_bf16 v129, v64, v89
    v_dot2c_f32_bf16 v130, v65, v88
    v_dot2c_f32_bf16 v131, v65, v89
    v_dot2c_f32_bf16 v132, v68, v88
    v_dot2c_f32_bf16 v133, v68, v89
    v_dot2c_f32_bf16 v134, v69, v88
    v_dot2c_f32_bf16 v135, v69, v89
    v_dot2c_f32_bf16 v136, v72, v88
    v_dot2c_f32_bf16 v137, v72, v89
    v_dot2c_f32_bf16 v138, v73, v88
    v_dot2c_f32_bf16 v139, v73, v89
    v_dot2c_f32_bf16 v128, v76, v88
    v_dot2c_f32_bf16 v129, v76, v89
    v_dot2c_f32_bf16 v130, v77, v88
    v_dot2c_f32_bf16 v131, v77, v89
    v_dot2c_f32_bf16 v132, v80, v88
    v_dot2c_f32_bf16 v133, v80, v89
    v_dot2c_f32_bf16 v134, v81, v88
    v_dot2c_f32_bf16 v135, v81, v89
    v_dot2c_f32_bf16 v136, v84, v88
    v_dot2c_f32_bf16 v137, v84, v89
    v_dot2c_f32_bf16 v138, v85, v88
    v_dot2c_f32_bf16 v139, v85, v89
    v_dot2c_f32_bf16 v128, v104, v88
    v_dot2c_f32_bf16 v129, v104, v89
    v_dot2c_f32_bf16 v130, v105, v88
    v_dot2c_f32_bf16 v131, v105, v89
    v_dot2c_f32_bf16 v132, v108, v88
    v_dot2c_f32_bf16 v133, v108, v89
    v_dot2c_f32_bf16 v134, v109, v88
    v_dot2c_f32_bf16 v135, v109, v89
    v_dot2c_f32_bf16 v136, v112, v88
    v_dot2c_f32_bf16 v137, v112, v89
    v_dot2c_f32_bf16 v138, v113, v88
    v_dot2c_f32_bf16 v139, v113, v89
    v_dot2c_f32_bf16 v128, v116, v88
    v_dot2c_f32_bf16 v129, v116, v89
    v_dot2c_f32_bf16 v130, v117, v88
    v_dot2c_f32_bf16 v131, v117, v89
    v_dot2c_f32_bf16 v132, v120, v88
    v_dot2c_f32_bf16 v133, v120, v89
    v_dot2c_f32_bf16 v134, v121, v88
    v_dot2c_f32_bf16 v135, v121, v89
    v_dot2c_f32_bf16 v136, v124, v88
    v_dot2c_f32_bf16 v137, v124, v89
    v_dot2c_f32_bf16 v138, v125, v88
    v_dot2c_f32_bf16 v139, v125, v89
    v_cvt_pk_bf16_f32 v64, v128, v129
    v_cvt_pk_bf16_f32 v65, v130, v131
    v_cvt_pk_bf16_f32 v66, v132, v133
    v_cvt_pk_bf16_f32 v67, v134, v135
    v_cvt_pk_bf16_f32 v68, v136, v137
    v_cvt_pk_bf16_f32 v69, v138, v139
    s_cmp_lg_u32 s42, 0
    s_cbranch_scc1 LA_ST0_69
    s_add_u32 s50, s37, 32
    s_mul_i32 s50, s50, 81920
    s_mul_i32 s51, s97, 10240
    s_add_u32 s50, s50, s51
    s_add_u32 s50, s50, 67108864
    buffer_load_dwordx4 v[144:147], v2, s[4:7], s50 offen offset:0 sc1
    buffer_load_dwordx4 v[148:151], v2, s[4:7], s50 offen offset:1024 sc1
    buffer_load_dwordx4 v[152:155], v2, s[4:7], s50 offen offset:2048 sc1
    buffer_load_dwordx4 v[156:159], v2, s[4:7], s50 offen offset:3072 sc1
    s_add_u32 s50, s50, 4096
    buffer_load_dwordx4 v[232:235], v2, s[4:7], s50 offen offset:0 sc1
    buffer_load_dwordx4 v[236:239], v2, s[4:7], s50 offen offset:1024 sc1
    buffer_load_dwordx4 v[240:243], v2, s[4:7], s50 offen offset:2048 sc1
    buffer_load_dwordx4 v[244:247], v2, s[4:7], s50 offen offset:3072 sc1
    s_add_u32 s50, s50, 4096
    buffer_load_dwordx4 v[248:251], v2, s[4:7], s50 offen offset:0 sc1
    buffer_load_dwordx4 v[252:255], v2, s[4:7], s50 offen offset:1024 sc1
    v_and_b32 v11, 31, v1
    v_lshlrev_b32 v11, 3, v11
    s_add_u32 s52, s37, 32
    s_lshl_b32 s52, s52, 11
    s_add_u32 s52, s52, 75497472
    buffer_load_dwordx2 v[160:161], v11, s[4:7], s52 offen offset:0 sc1
    buffer_load_dwordx2 v[162:163], v11, s[4:7], s52 offen offset:256 sc1
    buffer_load_dwordx2 v[164:165], v11, s[4:7], s52 offen offset:512 sc1
    buffer_load_dwordx2 v[166:167], v11, s[4:7], s52 offen offset:768 sc1
    buffer_load_dwordx2 v[168:169], v11, s[4:7], s52 offen offset:1024 sc1
    buffer_load_dwordx2 v[170:171], v11, s[4:7], s52 offen offset:1280 sc1
    buffer_load_dwordx2 v[172:173], v11, s[4:7], s52 offen offset:1536 sc1
    buffer_load_dwordx2 v[174:175], v11, s[4:7], s52 offen offset:1792 sc1
LA_ST0_69:
    ds_write_b128 v2, v[64:67] offset:53248
    v_lshlrev_b32 v13, 3, v1
    ds_write_b64 v13, v[68:69] offset:54272
W_64:
    s_waitcnt lgkmcnt(0)
    s_barrier
    v_lshlrev_b32 v13, 3, v1
    ds_read_b128 v[64:67], v2 offset:53248
    ds_read_b64 v[68:69], v13 offset:54272
    v_mov_b32 v70, 0
    v_mov_b32 v71, 0
    s_waitcnt lgkmcnt(0)
    v_mfma_f32_32x32x16_bf16 v[16:31], v[64:67], v[96:99], 0
    v_mfma_f32_32x32x16_bf16 v[16:31], v[68:71], v[100:103], v[16:31]
    s_lshl_b32 s50, s36, 4
    s_lshl_b32 s51, s43, 1
    s_add_u32 s50, s50, s51
    s_mul_i32 s50, s50, 21504
    s_add_u32 s50, s50, s47
    s_nop 6
    v_cndmask_b32 v10, v24, v28, s[44:45]
    v_add_f32 v10, 0x358637bd, v10
    v_rcp_f32 v10, v10
    s_nop 0
    v_mul_f32 v16, v10, v16
    v_mul_f32 v17, v10, v17
    v_mul_f32 v18, v10, v18
    v_mul_f32 v19, v10, v19
    v_mul_f32 v20, v10, v20
    v_mul_f32 v21, v10, v21
    v_mul_f32 v22, v10, v22
    v_mul_f32 v23, v10, v23
    v_mul_f32 v24, v10, v24
    v_mul_f32 v25, v10, v25
    v_mul_f32 v26, v10, v26
    v_mul_f32 v27, v10, v27
    v_cvt_pk_bf16_f32 v32, v16, v17
    v_cvt_pk_bf16_f32 v33, v18, v19
    v_cvt_pk_bf16_f32 v34, v20, v21
    v_cvt_pk_bf16_f32 v35, v22, v23
    v_cvt_pk_bf16_f32 v36, v24, v25
    v_cvt_pk_bf16_f32 v37, v26, v27
    buffer_store_dwordx2 v[32:33], v179, s[4:7], s50 offen
    buffer_store_dwordx2 v[34:35], v180, s[4:7], s50 offen
    s_mov_b64 exec, 0xffffffff
    buffer_store_dwordx2 v[36:37], v181, s[4:7], s50 offen
    s_mov_b64 exec, -1
    s_waitcnt vmcnt(0)
    s_cmp_lg_u32 s42, 0
    s_cbranch_scc1 CSB_70
    v_add_f32 v190, v160, v162
    v_add_f32 v191, v161, v163
    v_add_f32 v190, v190, v164
    v_add_f32 v191, v191, v165
    v_add_f32 v190, v190, v166
    v_add_f32 v191, v191, v167
    v_add_f32 v190, v190, v168
    v_add_f32 v191, v191, v169
    v_add_f32 v190, v190, v170
    v_add_f32 v191, v191, v171
    v_add_f32 v190, v190, v172
    v_add_f32 v191, v191, v173
    v_add_f32 v190, v190, v174
    v_add_f32 v191, v191, v175
CSB_70:
    s_branch L_ODONE
L_BLAYER:
    s_mov_b32 s96, 1
    s_mov_b32 s52, 0x3ea52b5c
    v_mul_f32 v102, s52, v101
    v_mul_f32 v28, v101, v28
    v_mul_f32 v29, v101, v29
    v_mul_f32 v30, v101, v30
    v_mul_f32 v31, v101, v31
    v_mul_f32 v32, v101, v32
    v_mul_f32 v33, v101, v33
    v_mul_f32 v34, v101, v34
    v_mul_f32 v35, v101, v35
    v_mul_f32 v36, v101, v36
    v_mul_f32 v37, v101, v37
    v_mul_f32 v38, v101, v38
    v_mul_f32 v39, v101, v39
    v_mul_f32 v40, v101, v40
    v_mul_f32 v41, v101, v41
    v_mul_f32 v42, v101, v42
    v_mul_f32 v43, v101, v43
    v_mul_f32 v44, v101, v44
    v_mul_f32 v45, v101, v45
    v_mul_f32 v46, v101, v46
    v_mul_f32 v47, v101, v47
    v_cvt_pk_bf16_f32 v106, v28, v29
    v_cvt_pk_bf16_f32 v107, v30, v31
    v_cvt_pk_bf16_f32 v108, v32, v33
    v_cvt_pk_bf16_f32 v109, v34, v35
    v_cvt_pk_bf16_f32 v110, v36, v37
    v_cvt_pk_bf16_f32 v111, v38, v39
    v_cvt_pk_bf16_f32 v112, v40, v41
    v_cvt_pk_bf16_f32 v113, v42, v43
    v_cvt_pk_bf16_f32 v114, v44, v45
    v_cvt_pk_bf16_f32 v115, v46, v47
    ds_write_b64 v4, v[108:109]
    ds_write_b64 v5, v[106:107]
    ds_write_b64 v6, v[110:111]
    ds_write_b64 v6, v[112:113] offset:16
    ds_write_b64 v7, v[114:115]
    v_mov_b32 v12, 0x3f80
    v_mov_b32 v13, 0
    v_cndmask_b32 v12, v12, v13, s[44:45]
    ds_write_b64 v8, v[12:13]
    v_mul_f32 v118, v28, v28
    v_fmac_f32 v118, v29, v29
    v_fmac_f32 v118, v30, v30
    v_fmac_f32 v118, v31, v31
    v_fmac_f32 v118, v32, v32
    v_fmac_f32 v118, v33, v33
    v_fmac_f32 v118, v34, v34
    v_fmac_f32 v118, v35, v35
    v_mul_f32 v119, v44, v44
    v_fmac_f32 v119, v45, v45
    v_fmac_f32 v119, v46, v46
    v_fmac_f32 v119, v47, v47
    v_mov_b32 v13, 0
    v_cndmask_b32 v119, v13, v119, s[44:45]
    v_add_f32 v118, v118, v119
    v_mov_b32 v119, v118
    s_nop 1
    v_permlane32_swap_b32 v118, v119
    v_add_f32 v118, v118, v119
    s_waitcnt lgkmcnt(0)
    s_cmp_eq_u32 s36, 7
    s_cbranch_scc1 EB_NOEXP_71
    s_mul_i32 s50, s43, 1536
    v_add_u32 v60, s50, v2
    v_add_u32 v62, 12800, v60
    v_add_u32 v61, 1024, v60
    v_add_u32 v63, 11776, v60
    v_cndmask_b32 v61, v63, v61, s[44:45]
    v_add_u32 v63, 12288, v61
    v_add_u32 v10, 24576, v61
    v_cndmask_b32 v63, v10, v63, s[44:45]
    ds_read_b128 v[48:51], v60 offset:12288
    ds_read_b128 v[52:55], v63
    ds_read_b128 v[56:59], v62 offset:24576
    s_lshr_b32 s51, s42, 1
    s_mul_i32 s51, s51, 6291456
    s_add_u32 s51, s51, 35651584
    s_mul_i32 s63, s2, 24576
    s_add_u32 s51, s51, s63
    s_waitcnt lgkmcnt(0)
    buffer_store_dwordx4 v[48:51], v60, s[4:7], s51 offen sc1
    buffer_store_dwordx4 v[52:55], v61, s[4:7], s51 offen sc1
    buffer_store_dwordx4 v[56:59], v62, s[4:7], s51 offen sc1
EB_NOEXP_71:
    v_mov_b32_dpp v117, v118 row_ror:8 row_mask:0xf bank_mask:0xf
    v_max_f32 v118, v118, v117
    s_nop 1
    v_mov_b32_dpp v117, v118 row_ror:4 row_mask:0xf bank_mask:0xf
    v_max_f32 v118, v118, v117
    s_nop 1
    v_mov_b32_dpp v117, v118 row_ror:2 row_mask:0xf bank_mask:0xf
    v_max_f32 v118, v118, v117
    s_nop 1
    v_mov_b32_dpp v117, v118 row_ror:1 row_mask:0xf bank_mask:0xf
    v_max_f32 v118, v118, v117
    v_mov_b32 v117, v118
    s_nop 1
    v_permlane16_swap_b32 v118, v117
    v_max_f32 v118, v118, v117
    v_mov_b32 v117, v118
    s_nop 1
    v_permlane32_swap_b32 v118, v117
    v_max_f32 v118, v118, v117
    s_cmp_eq_u32 s36, 7
    s_cbranch_scc1 EB_NOEXP2_72
    s_lshl_b32 s52, s2, 6
    s_add_u32 s52, s52, 32768
    s_lshl_b32 s53, s43, 2
    v_mov_b32 v12, s53
    s_mov_b64 exec, 1
    buffer_store_dword v118, v12, s[4:7], s52 offen sc1
    s_mov_b64 exec, -1
EB_NOEXP2_72:
    s_lshl_b32 s50, s38, 2
    v_mov_b32 v12, s50
    s_mov_b64 exec, 1
    ds_write_b32 v12, v118 offset:51200
    s_mov_b64 exec, -1
    s_cmp_lg_u32 s38, 0
    s_cbranch_scc1 W_73
    v_lshlrev_b32 v12, 2, v1
    v_mov_b32 v13, 0
    s_mov_b64 exec, 0xff
    ds_write_b32 v12, v13 offset:51232
    s_mov_b64 exec, -1
W_73:
    s_cmp_ge_u32 s38, 4
    s_cbranch_scc1 W_74
    v_mul_f32 v16, v102, v16
    v_mul_f32 v17, v102, v17
    v_mul_f32 v18, v102, v18
    v_mul_f32 v19, v102, v19
    v_mul_f32 v20, v102, v20
    v_mul_f32 v21, v102, v21
    v_mul_f32 v22, v102, v22
    v_mul_f32 v23, v102, v23
    v_mul_f32 v24, v102, v24
    v_mul_f32 v25, v102, v25
    v_mul_f32 v26, v102, v26
    v_mul_f32 v27, v102, v27
    v_cvt_pk_bf16_f32 v96, v16, v17
    v_cvt_pk_bf16_f32 v97, v18, v19
    v_cvt_pk_bf16_f32 v98, v20, v21
    v_cvt_pk_bf16_f32 v99, v22, v23
    v_cvt_pk_bf16_f32 v100, v24, v25
    v_cvt_pk_bf16_f32 v101, v26, v27
    v_mul_f32 v116, v16, v16
    v_fmac_f32 v116, v17, v17
    v_fmac_f32 v116, v18, v18
    v_fmac_f32 v116, v19, v19
    v_fmac_f32 v116, v20, v20
    v_fmac_f32 v116, v21, v21
    v_fmac_f32 v116, v22, v22
    v_fmac_f32 v116, v23, v23
    v_mul_f32 v117, v24, v24
    v_fmac_f32 v117, v25, v25
    v_fmac_f32 v117, v26, v26
    v_fmac_f32 v117, v27, v27
    v_mov_b32 v13, 0
    v_mov_b32 v102, 0x3f80
    v_mov_b32 v103, 0
    v_cndmask_b32 v100, v13, v100, s[44:45]
    v_cndmask_b32 v101, v13, v101, s[44:45]
    v_cndmask_b32 v102, v13, v102, s[44:45]
    v_cndmask_b32 v117, v13, v117, s[44:45]
    v_add_f32 v116, v116, v117
    v_mov_b32 v117, v116
    s_nop 1
    v_permlane32_swap_b32 v116, v117
    v_add_f32 v104, v116, v117
    s_nop 1
    v_mov_b32_dpp v116, v104 row_ror:8 row_mask:0xf bank_mask:0xf
    v_max_f32 v104, v104, v116
    s_nop 1
    v_mov_b32_dpp v116, v104 row_ror:4 row_mask:0xf bank_mask:0xf
    v_max_f32 v104, v104, v116
    s_nop 1
    v_mov_b32_dpp v116, v104 row_ror:2 row_mask:0xf bank_mask:0xf
    v_max_f32 v104, v104, v116
    s_nop 1
    v_mov_b32_dpp v116, v104 row_ror:1 row_mask:0xf bank_mask:0xf
    v_max_f32 v104, v104, v116
    v_mov_b32 v116, v104
    s_nop 1
    v_permlane16_swap_b32 v104, v116
    v_max_f32 v104, v104, v116
    v_mov_b32 v116, v104
    s_nop 1
    v_permlane32_swap_b32 v104, v116
    v_max_f32 v104, v104, v116
W_74:
    ds_read_b128 v[32:35], v2 offset:55296
    ds_read_b128 v[36:39], v2 offset:56320
    ds_read_b128 v[40:43], v2 offset:57344
    ds_read_b128 v[44:47], v2 offset:58368
    s_cmp_ge_u32 s38, 4
    s_cbranch_scc1 W_75
    s_cmp_eq_u32 s36, 7
    s_cbranch_scc1 EB_J7_76
    s_waitcnt vmcnt(0)
    s_lshl_b32 s53, s43, 2
    s_add_u32 s53, s53, 32
    s_add_u32 s54, s42, 1
    s_lshl_b32 s52, s2, 6
    s_add_u32 s52, s52, 16384
    s_add_u32 s52, s52, s53
    s_add_u32 s63, s93, s54
    v_mov_b32 v11, s63
    v_mov_b32 v12, 0
    s_mov_b64 exec, 1
    buffer_store_dword v11, v12, s[4:7], s52 offen sc1
    s_mov_b64 exec, -1
EB_J7_76:
    s_cmp_lg_u32 s38, 0
    s_cbranch_scc1 W_77
    s_mov_b32 s96, 0
    s_cmp_eq_u32 s36, 0
    s_cbranch_scc1 S1_E_78
    s_sub_u32 s54, s2, 1
    s_lshl_b32 s52, s54, 6
    s_add_u32 s52, s52, 16384
    v_and_b32 v11, 3, v1
    v_lshlrev_b32 v11, 2, v11
    v_add_u32 v11, 48, v11
    s_mov_b32 s60, 0
    s_add_u32 s63, s93, s42
    s_add_u32 s63, s63, 1
S1_TRY_80:
    buffer_load_dword v12, v11, s[4:7], s52 offen sc1
    s_waitcnt vmcnt(0)
    v_subrev_u32 v12, s63, v12
    v_cmp_lt_u32 vcc, 7, v12
    s_nop 3
    s_and_b32 s61, vcc_lo, 0xf
    s_cmp_eq_u32 s61, 0
    s_cbranch_scc1 S1_OK_81
    s_add_u32 s60, s60, 1
    s_cmp_lt_u32 s60, 2
    s_cbranch_scc1 S1_TRY_80
    s_mov_b32 s96, 1
    s_branch S1_E_78
S1_OK_81:
    s_lshr_b32 s51, s42, 1
    s_mul_i32 s51, s51, 6291456
    s_add_u32 s51, s51, 35651584
    s_mul_i32 s63, s54, 24576
    s_add_u32 s51, s51, s63
    s_add_u32 s55, s51, 18432
    s_add_u32 s51, s51, 6144
    s_lshl_b32 s52, s54, 6
    s_add_u32 s52, s52, 32784
    v_and_b32 v11, 3, v1
    v_lshlrev_b32 v11, 2, v11
    buffer_load_dword v14, v11, s[4:7], s52 offen sc1
    buffer_load_dwordx4 v[160:163], v2, s[4:7], s51 offen offset:0 sc1
    buffer_load_dwordx4 v[164:167], v2, s[4:7], s51 offen offset:1024 sc1
    buffer_load_dwordx4 v[168:171], v2, s[4:7], s51 offen offset:2048 sc1
    buffer_load_dwordx4 v[172:175], v2, s[4:7], s51 offen offset:3072 sc1
    s_add_u32 s51, s51, 4096
    buffer_load_dwordx4 v[184:187], v2, s[4:7], s51 offen offset:0 sc1
    buffer_load_dwordx4 v[108:111], v2, s[4:7], s51 offen offset:1024 sc1
    buffer_load_dwordx4 v[128:131], v2, s[4:7], s55 offen offset:0 sc1
    buffer_load_dwordx4 v[132:135], v2, s[4:7], s55 offen offset:1024 sc1
    buffer_load_dwordx4 v[136:139], v2, s[4:7], s55 offen offset:2048 sc1
    buffer_load_dwordx4 v[140:143], v2, s[4:7], s55 offen offset:3072 sc1
    s_add_u32 s55, s55, 4096
    buffer_load_dwordx4 v[48:51], v2, s[4:7], s55 offen offset:0 sc1
    buffer_load_dwordx4 v[52:55], v2, s[4:7], s55 offen offset:1024 sc1
S1_E_78:
    v_mov_b32 v11, 52224
    v_mov_b32 v12, s96
    ds_write_b32 v11, v12 offset:16
W_77:
W_75:
    s_waitcnt lgkmcnt(0)
    s_barrier
    s_cmp_lt_u32 s38, 4
    s_cbranch_scc1 W_82
    v_mul_f32 v16, v102, v16
    v_mul_f32 v17, v102, v17
    v_mul_f32 v18, v102, v18
    v_mul_f32 v19, v102, v19
    v_mul_f32 v20, v102, v20
    v_mul_f32 v21, v102, v21
    v_mul_f32 v22, v102, v22
    v_mul_f32 v23, v102, v23
    v_mul_f32 v24, v102, v24
    v_mul_f32 v25, v102, v25
    v_mul_f32 v26, v102, v26
    v_mul_f32 v27, v102, v27
    v_cvt_pk_bf16_f32 v96, v16, v17
    v_cvt_pk_bf16_f32 v97, v18, v19
    v_cvt_pk_bf16_f32 v98, v20, v21
    v_cvt_pk_bf16_f32 v99, v22, v23
    v_cvt_pk_bf16_f32 v100, v24, v25
    v_cvt_pk_bf16_f32 v101, v26, v27
    v_mul_f32 v116, v16, v16
    v_fmac_f32 v116, v17, v17
    v_fmac_f32 v116, v18, v18
    v_fmac_f32 v116, v19, v19
    v_fmac_f32 v116, v20, v20
    v_fmac_f32 v116, v21, v21
    v_fmac_f32 v116, v22, v22
    v_fmac_f32 v116, v23, v23
    v_mul_f32 v117, v24, v24
    v_fmac_f32 v117, v25, v25
    v_fmac_f32 v117, v26, v26
    v_fmac_f32 v117, v27, v27
    v_mov_b32 v13, 0
    v_mov_b32 v102, 0x3f80
    v_mov_b32 v103, 0
    v_cndmask_b32 v100, v13, v100, s[44:45]
    v_cndmask_b32 v101, v13, v101, s[44:45]
    v_cndmask_b32 v102, v13, v102, s[44:45]
    v_cndmask_b32 v117, v13, v117, s[44:45]
    v_add_f32 v116, v116, v117
    v_mov_b32 v117, v116
    s_nop 1
    v_permlane32_swap_b32 v116, v117
    v_add_f32 v104, v116, v117
    s_nop 1
    v_mov_b32_dpp v116, v104 row_ror:8 row_mask:0xf bank_mask:0xf
    v_max_f32 v104, v104, v116
    s_nop 1
    v_mov_b32_dpp v116, v104 row_ror:4 row_mask:0xf bank_mask:0xf
    v_max_f32 v104, v104, v116
    s_nop 1
    v_mov_b32_dpp v116, v104 row_ror:2 row_mask:0xf bank_mask:0xf
    v_max_f32 v104, v104, v116
    s_nop 1
    v_mov_b32_dpp v116, v104 row_ror:1 row_mask:0xf bank_mask:0xf
    v_max_f32 v104, v104, v116
    v_mov_b32 v116, v104
    s_nop 1
    v_permlane16_swap_b32 v104, v116
    v_max_f32 v104, v104, v116
    v_mov_b32 v116, v104
    s_nop 1
    v_permlane32_swap_b32 v104, v116
    v_max_f32 v104, v104, v116
W_82:
    s_cmp_lt_u32 s38, 4
    s_cbranch_scc1 W_88
    s_setprio 1
W_88:
    s_cmp_lg_u32 s38, 0
    s_cbranch_scc1 W_89
    s_cmp_lg_u32 s96, 0
    s_cbranch_scc1 AT_W0N_90
    s_call_b64 s[88:89], SUB_S1FIN
AT_W0N_90:
W_89:
    v_and_b32 v11, 15, v1
    v_lshlrev_b32 v11, 2, v11
    ds_read_b32 v12, v11 offset:51200
    s_waitcnt lgkmcnt(0)
    v_mov_b32_dpp v13, v12 row_ror:8 row_mask:0xf bank_mask:0xf
    v_max_f32 v12, v12, v13
    s_nop 1
    v_mov_b32_dpp v13, v12 row_ror:4 row_mask:0xf bank_mask:0xf
    v_max_f32 v12, v12, v13
    s_nop 1
    v_mov_b32_dpp v13, v12 row_ror:2 row_mask:0xf bank_mask:0xf
    v_max_f32 v12, v12, v13
    s_nop 1
    v_mov_b32_dpp v13, v12 row_ror:1 row_mask:0xf bank_mask:0xf
    v_max_f32 v12, v12, v13
    v_mul_f32 v12, v104, v12
    s_mov_b32 s50, 0x45440000
    v_mov_b32 v13, s50
    v_cmp_nle_f32 vcc, v12, v13
    s_nop 3
    s_cmp_lg_u64 vcc, 0
    s_cbranch_scc1 AT_FB1_83
    ds_read_b128 v[80:83], v176 offset:12288
    ds_read_b128 v[84:87], v177 offset:12288
    ds_read_b64_tr_b16 v[64:65], v178 offset:12288
    ds_read_b64_tr_b16 v[66:67], v178 offset:12672
    ds_read_b64_tr_b16 v[68:69], v178 offset:13056
    ds_read_b64_tr_b16 v[70:71], v178 offset:13440
    s_waitcnt lgkmcnt(4)
    v_mfma_f32_32x32x16_bf16 v[112:127], v[80:83], v[96:99], v[32:47]
    v_mfma_f32_32x32x16_bf16 v[112:127], v[84:87], v[100:103], v[112:127]
    s_cmp_lt_u32 s38, 4
    s_cbranch_scc1 W_91
    s_cmp_eq_u32 s36, 7
    s_cbranch_scc1 LF_E_92
    s_waitcnt vmcnt(0)
    s_lshl_b32 s53, s43, 2
    s_add_u32 s53, s53, 32
    s_add_u32 s54, s42, 1
    s_lshl_b32 s52, s2, 6
    s_add_u32 s52, s52, 16384
    s_add_u32 s52, s52, s53
    s_add_u32 s63, s93, s54
    v_mov_b32 v11, s63
    v_mov_b32 v12, 0
    s_mov_b64 exec, 1
    buffer_store_dword v11, v12, s[4:7], s52 offen sc1
    s_mov_b64 exec, -1
LF_E_92:
W_91:
    s_cmp_lg_u32 s38, 4
    s_cbranch_scc1 W_93
    v_mov_b32 v11, 52224
    ds_read_b32 v12, v11 offset:16
    s_waitcnt lgkmcnt(0)
    v_readfirstlane_b32 s61, v12
    s_nop 3
    s_cmp_eq_u32 s61, 0
    s_cbranch_scc1 S1_D_94
    s_call_b64 s[88:89], SUB_IMPORT1
S1_D_94:
W_93:
    s_cmp_lg_u32 s43, 0
    s_cbranch_scc1 AT_SY_95
    s_add_u32 s62, s42, 1
    s_lshr_b32 s62, s62, 1
    v_mov_b32 v11, 52232
    s_mov_b32 s60, 0
CW_96:
    ds_read_b32 v12, v11
    s_waitcnt lgkmcnt(0)
    v_readfirstlane_b32 s61, v12
    s_nop 3
    s_cmp_ge_u32 s61, s62
    s_cbranch_scc1 CWD_97
    s_sleep 1
    s_add_u32 s60, s60, 1
    s_cmp_lt_u32 s60, 0x200000
    s_cbranch_scc1 CW_96
CWD_97:
    v_and_b32 v11, 15, v1
    v_lshlrev_b32 v11, 2, v11
    ds_read_b32 v12, v11 offset:51200
    s_waitcnt lgkmcnt(0)
    v_mov_b32_dpp v13, v12 row_ror:8 row_mask:0xf bank_mask:0xf
    v_max_f32 v12, v12, v13
    s_nop 1
    v_mov_b32_dpp v13, v12 row_ror:4 row_mask:0xf bank_mask:0xf
    v_max_f32 v12, v12, v13
    s_nop 1
    v_mov_b32_dpp v13, v12 row_ror:2 row_mask:0xf bank_mask:0xf
    v_max_f32 v12, v12, v13
    s_nop 1
    v_mov_b32_dpp v13, v12 row_ror:1 row_mask:0xf bank_mask:0xf
    v_max_f32 v12, v12, v13
    v_mul_f32 v12, v104, v12
    s_mov_b32 s50, 0x45440000
    v_mov_b32 v13, s50
    v_cmp_nle_f32 vcc, v12, v13
    s_nop 3
    s_cmp_lg_u64 vcc, 0
    s_cbranch_scc1 AT_FB2_84
AT_SY_95:
    ds_read_b128 v[88:91], v176 offset:10752
    ds_read_b128 v[92:95], v177 offset:10752
    v_exp_f32 v112, v112
    v_exp_f32 v113, v113
    v_exp_f32 v114, v114
    v_exp_f32 v115, v115
    ds_read_b64_tr_b16 v[72:73], v178 offset:10752
    ds_read_b64_tr_b16 v[74:75], v178 offset:11136
    ds_read_b64_tr_b16 v[76:77], v178 offset:11520
    ds_read_b64_tr_b16 v[78:79], v178 offset:11904
    s_waitcnt lgkmcnt(4)
    v_mfma_f32_32x32x16_bf16 v[128:143], v[88:91], v[96:99], 0
    v_exp_f32 v116, v116
    v_exp_f32 v117, v117
    v_exp_f32 v118, v118
    v_exp_f32 v119, v119
    v_cvt_pk_bf16_f32 v112, v112, v113
    v_cvt_pk_bf16_f32 v113, v114, v115
    v_exp_f32 v120, v120
    v_exp_f32 v121, v121
    v_exp_f32 v122, v122
    v_exp_f32 v123, v123
    v_mfma_f32_32x32x16_bf16 v[128:143], v[92:95], v[100:103], v[128:143]
    v_cvt_pk_bf16_f32 v114, v116, v117
    v_cvt_pk_bf16_f32 v115, v118, v119
    v_exp_f32 v124, v124
    v_exp_f32 v125, v125
    v_exp_f32 v126, v126
    v_exp_f32 v127, v127
    v_mfma_f32_32x32x16_bf16 v[16:31], v[64:67], v[112:115], 0
    v_cvt_pk_bf16_f32 v116, v120, v121
    v_cvt_pk_bf16_f32 v117, v122, v123
    v_cvt_pk_bf16_f32 v118, v124, v125
    v_cvt_pk_bf16_f32 v119, v126, v127
    s_cmp_lg_u32 s43, 1
    s_cbranch_scc1 AT_SY_98
    s_add_u32 s62, s42, 1
    s_lshr_b32 s62, s62, 1
    v_mov_b32 v11, 52232
    s_mov_b32 s60, 0
CW_99:
    ds_read_b32 v12, v11
    s_waitcnt lgkmcnt(0)
    v_readfirstlane_b32 s61, v12
    s_nop 3
    s_cmp_ge_u32 s61, s62
    s_cbranch_scc1 CWD_100
    s_sleep 1
    s_add_u32 s60, s60, 1
    s_cmp_lt_u32 s60, 0x200000
    s_cbranch_scc1 CW_99
CWD_100:
    v_and_b32 v11, 15, v1
    v_lshlrev_b32 v11, 2, v11
    ds_read_b32 v12, v11 offset:51200
    s_waitcnt lgkmcnt(0)
    v_mov_b32_dpp v13, v12 row_ror:8 row_mask:0xf bank_mask:0xf
    v_max_f32 v12, v12, v13
    s_nop 1
    v_mov_b32_dpp v13, v12 row_ror:4 row_mask:0xf bank_mask:0xf
    v_max_f32 v12, v12, v13
    s_nop 1
    v_mov_b32_dpp v13, v12 row_ror:2 row_mask:0xf bank_mask:0xf
    v_max_f32 v12, v12, v13
    s_nop 1
    v_mov_b32_dpp v13, v12 row_ror:1 row_mask:0xf bank_mask:0xf
    v_max_f32 v12, v12, v13
    v_mul_f32 v12, v104, v12
    s_mov_b32 s50, 0x45440000
    v_mov_b32 v13, s50
    v_cmp_nle_f32 vcc, v12, v13
    s_nop 3
    s_cmp_lg_u64 vcc, 0
    s_cbranch_scc1 AT_FB2_84
AT_SY_98:
    s_cmp_lt_u32 s38, 6
    s_cbranch_scc1 W_101
    s_cmp_eq_u32 s36, 0
    s_cbranch_scc1 AT_J0_102
    s_sub_u32 s54, s2, 1
    s_lshl_b32 s52, s54, 6
    s_add_u32 s52, s52, 16384
    v_and_b32 v11, 3, v1
    v_lshlrev_b32 v11, 2, v11
    v_add_u32 v11, 32, v11
    buffer_load_dword v182, v11, s[4:7], s52 offen sc1
AT_J0_102:
W_101:
    ds_read_b128 v[80:83], v176 offset:9216
    ds_read_b128 v[84:87], v177 offset:9216
    v_exp_f32 v128, v128
    v_exp_f32 v129, v129
    v_exp_f32 v130, v130
    v_exp_f32 v131, v131
    v_mfma_f32_32x32x16_bf16 v[16:31], v[68:71], v[116:119], v[16:31]
    ds_read_b64_tr_b16 v[64:65], v178 offset:9216
    ds_read_b64_tr_b16 v[66:67], v178 offset:9600
    ds_read_b64_tr_b16 v[68:69], v178 offset:9984
    ds_read_b64_tr_b16 v[70:71], v178 offset:10368
    s_waitcnt lgkmcnt(4)
    v_mfma_f32_32x32x16_bf16 v[112:127], v[80:83], v[96:99], 0
    v_exp_f32 v132, v132
    v_exp_f32 v133, v133
    v_exp_f32 v134, v134
    v_exp_f32 v135, v135
    v_cvt_pk_bf16_f32 v128, v128, v129
    v_cvt_pk_bf16_f32 v129, v130, v131
    v_exp_f32 v136, v136
    v_exp_f32 v137, v137
    v_exp_f32 v138, v138
    v_exp_f32 v139, v139
    v_mfma_f32_32x32x16_bf16 v[112:127], v[84:87], v[100:103], v[112:127]
    v_cvt_pk_bf16_f32 v130, v132, v133
    v_cvt_pk_bf16_f32 v131, v134, v135
    v_exp_f32 v140, v140
    v_exp_f32 v141, v141
    v_exp_f32 v142, v142
    v_exp_f32 v143, v143
    v_mfma_f32_32x32x16_bf16 v[16:31], v[72:75], v[128:131], v[16:31]
    v_cvt_pk_bf16_f32 v132, v136, v137
    v_cvt_pk_bf16_f32 v133, v138, v139
    v_cvt_pk_bf16_f32 v134, v140, v141
    v_cvt_pk_bf16_f32 v135, v142, v143
    s_cmp_lg_u32 s43, 2
    s_cbranch_scc1 AT_SY_103
    s_add_u32 s62, s42, 1
    s_lshr_b32 s62, s62, 1
    v_mov_b32 v11, 52232
    s_mov_b32 s60, 0
CW_104:
    ds_read_b32 v12, v11
    s_waitcnt lgkmcnt(0)
    v_readfirstlane_b32 s61, v12
    s_nop 3
    s_cmp_ge_u32 s61, s62
    s_cbranch_scc1 CWD_105
    s_sleep 1
    s_add_u32 s60, s60, 1
    s_cmp_lt_u32 s60, 0x200000
    s_cbranch_scc1 CW_104
CWD_105:
    v_and_b32 v11, 15, v1
    v_lshlrev_b32 v11, 2, v11
    ds_read_b32 v12, v11 offset:51200
    s_waitcnt lgkmcnt(0)
    v_mov_b32_dpp v13, v12 row_ror:8 row_mask:0xf bank_mask:0xf
    v_max_f32 v12, v12, v13
    s_nop 1
    v_mov_b32_dpp v13, v12 row_ror:4 row_mask:0xf bank_mask:0xf
    v_max_f32 v12, v12, v13
    s_nop 1
    v_mov_b32_dpp v13, v12 row_ror:2 row_mask:0xf bank_mask:0xf
    v_max_f32 v12, v12, v13
    s_nop 1
    v_mov_b32_dpp v13, v12 row_ror:1 row_mask:0xf bank_mask:0xf
    v_max_f32 v12, v12, v13
    v_mul_f32 v12, v104, v12
    s_mov_b32 s50, 0x45440000
    v_mov_b32 v13, s50
    v_cmp_nle_f32 vcc, v12, v13
    s_nop 3
    s_cmp_lg_u64 vcc, 0
    s_cbranch_scc1 AT_FB2_84
AT_SY_103:
    s_cmp_lt_u32 s38, 6
    s_cbranch_scc1 W_106
    s_cmp_eq_u32 s36, 0
    s_cbranch_scc1 AT_J0_107
    s_waitcnt vmcnt(0)
    s_add_u32 s63, s93, s42
    s_add_u32 s63, s63, 1
    v_subrev_u32 v182, s63, v182
    v_cmp_lt_u32 vcc, 7, v182
    s_nop 3
    s_and_b32 s61, vcc_lo, 0xf
    s_cmp_eq_u32 s61, 0
    s_cbranch_scc0 I2T_N_108
    s_sub_u32 s54, s2, 1
    s_lshr_b32 s51, s42, 1
    s_mul_i32 s51, s51, 6291456
    s_add_u32 s51, s51, 35651584
    s_mul_i32 s63, s54, 24576
    s_add_u32 s51, s51, s63
    s_sub_u32 s55, s38, 6
    s_mul_i32 s55, s55, 12288
    s_add_u32 s51, s51, s55
    s_lshl_b32 s52, s54, 6
    s_add_u32 s52, s52, 32768
    v_and_b32 v11, 3, v1
    v_lshlrev_b32 v11, 2, v11
    buffer_load_dword v183, v11, s[4:7], s52 offen sc1
    buffer_load_dwordx4 v[160:163], v2, s[4:7], s51 offen offset:0 sc1
    buffer_load_dwordx4 v[164:167], v2, s[4:7], s51 offen offset:1024 sc1
    buffer_load_dwordx4 v[168:171], v2, s[4:7], s51 offen offset:2048 sc1
    buffer_load_dwordx4 v[172:175], v2, s[4:7], s51 offen offset:3072 sc1
    s_add_u32 s51, s51, 4096
    buffer_load_dwordx4 v[184:187], v2, s[4:7], s51 offen offset:0 sc1
    buffer_load_dwordx4 v[108:111], v2, s[4:7], s51 offen offset:1024 sc1
    s_mov_b32 s96, 0
    s_branch I2T_E_109
I2T_N_108:
    s_mov_b32 s96, 1
I2T_E_109:
    s_cmp_eq_u32 s96, 0
    s_cbranch_scc1 AT_R2_110
    s_sub_u32 s54, s2, 1
    s_lshl_b32 s52, s54, 6
    s_add_u32 s52, s52, 16384
    v_and_b32 v11, 3, v1
    v_lshlrev_b32 v11, 2, v11
    v_add_u32 v11, 32, v11
    buffer_load_dword v182, v11, s[4:7], s52 offen sc1
AT_R2_110:
AT_J0_107:
W_106:
    ds_read_b128 v[88:91], v176 offset:7680
    ds_read_b128 v[92:95], v177 offset:7680
    v_exp_f32 v112, v112
    v_exp_f32 v113, v113
    v_exp_f32 v114, v114
    v_exp_f32 v115, v115
    v_mfma_f32_32x32x16_bf16 v[16:31], v[76:79], v[132:135], v[16:31]
    ds_read_b64_tr_b16 v[72:73], v178 offset:7680
    ds_read_b64_tr_b16 v[74:75], v178 offset:8064
    ds_read_b64_tr_b16 v[76:77], v178 offset:8448
    ds_read_b64_tr_b16 v[78:79], v178 offset:8832
    s_waitcnt lgkmcnt(4)
    v_mfma_f32_32x32x16_bf16 v[128:143], v[88:91], v[96:99], 0
    v_exp_f32 v116, v116
    v_exp_f32 v117, v117
    v_exp_f32 v118, v118
    v_exp_f32 v119, v119
    v_cvt_pk_bf16_f32 v112, v112, v113
    v_cvt_pk_bf16_f32 v113, v114, v115
    v_exp_f32 v120, v120
    v_exp_f32 v121, v121
    v_exp_f32 v122, v122
    v_exp_f32 v123, v123
    v_mfma_f32_32x32x16_bf16 v[128:143], v[92:95], v[100:103], v[128:143]
    v_cvt_pk_bf16_f32 v114, v116, v117
    v_cvt_pk_bf16_f32 v115, v118, v119
    v_exp_f32 v124, v124
    v_exp_f32 v125, v125
    v_exp_f32 v126, v126
    v_exp_f32 v127, v127
    v_mfma_f32_32x32x16_bf16 v[16:31], v[64:67], v[112:115], v[16:31]
    v_cvt_pk_bf16_f32 v116, v120, v121
    v_cvt_pk_bf16_f32 v117, v122, v123
    v_cvt_pk_bf16_f32 v118, v124, v125
    v_cvt_pk_bf16_f32 v119, v126, v127
    s_cmp_lg_u32 s43, 3
    s_cbranch_scc1 AT_SY_111
    s_add_u32 s62, s42, 1
    s_lshr_b32 s62, s62, 1
    v_mov_b32 v11, 52232
    s_mov_b32 s60, 0
CW_112:
    ds_read_b32 v12, v11
    s_waitcnt lgkmcnt(0)
    v_readfirstlane_b32 s61, v12
    s_nop 3
    s_cmp_ge_u32 s61, s62
    s_cbranch_scc1 CWD_113
    s_sleep 1
    s_add_u32 s60, s60, 1
    s_cmp_lt_u32 s60, 0x200000
    s_cbranch_scc1 CW_112
CWD_113:
    v_and_b32 v11, 15, v1
    v_lshlrev_b32 v11, 2, v11
    ds_read_b32 v12, v11 offset:51200
    s_waitcnt lgkmcnt(0)
    v_mov_b32_dpp v13, v12 row_ror:8 row_mask:0xf bank_mask:0xf
    v_max_f32 v12, v12, v13
    s_nop 1
    v_mov_b32_dpp v13, v12 row_ror:4 row_mask:0xf bank_mask:0xf
    v_max_f32 v12, v12, v13
    s_nop 1
    v_mov_b32_dpp v13, v12 row_ror:2 row_mask:0xf bank_mask:0xf
    v_max_f32 v12, v12, v13
    s_nop 1
    v_mov_b32_dpp v13, v12 row_ror:1 row_mask:0xf bank_mask:0xf
    v_max_f32 v12, v12, v13
    v_mul_f32 v12, v104, v12
    s_mov_b32 s50, 0x45440000
    v_mov_b32 v13, s50
    v_cmp_nle_f32 vcc, v12, v13
    s_nop 3
    s_cmp_lg_u64 vcc, 0
    s_cbranch_scc1 AT_FB2_84
AT_SY_111:
    s_cmp_lt_u32 s38, 6
    s_cbranch_scc1 W_114
    s_cmp_eq_u32 s36, 0
    s_cbranch_scc1 AT_J0_115
    s_cmp_eq_u32 s96, 0
    s_cbranch_scc1 AT_J0_115
    s_waitcnt vmcnt(0)
    s_add_u32 s63, s93, s42
    s_add_u32 s63, s63, 1
    v_subrev_u32 v182, s63, v182
    v_cmp_lt_u32 vcc, 7, v182
    s_nop 3
    s_and_b32 s61, vcc_lo, 0xf
    s_cmp_eq_u32 s61, 0
    s_cbranch_scc0 I2T_N_116
    s_sub_u32 s54, s2, 1
    s_lshr_b32 s51, s42, 1
    s_mul_i32 s51, s51, 6291456
    s_add_u32 s51, s51, 35651584
    s_mul_i32 s63, s54, 24576
    s_add_u32 s51, s51, s63
    s_sub_u32 s55, s38, 6
    s_mul_i32 s55, s55, 12288
    s_add_u32 s51, s51, s55
    s_lshl_b32 s52, s54, 6
    s_add_u32 s52, s52, 32768
    v_and_b32 v11, 3, v1
    v_lshlrev_b32 v11, 2, v11
    buffer_load_dword v183, v11, s[4:7], s52 offen sc1
    buffer_load_dwordx4 v[160:163], v2, s[4:7], s51 offen offset:0 sc1
    buffer_load_dwordx4 v[164:167], v2, s[4:7], s51 offen offset:1024 sc1
    buffer_load_dwordx4 v[168:171], v2, s[4:7], s51 offen offset:2048 sc1
    buffer_load_dwordx4 v[172:175], v2, s[4:7], s51 offen offset:3072 sc1
    s_add_u32 s51, s51, 4096
    buffer_load_dwordx4 v[184:187], v2, s[4:7], s51 offen offset:0 sc1
    buffer_load_dwordx4 v[108:111], v2, s[4:7], s51 offen offset:1024 sc1
    s_mov_b32 s96, 0
    s_branch I2T_E_117
I2T_N_116:
    s_mov_b32 s96, 1
I2T_E_117:
AT_J0_115:
W_114:
    ds_read_b128 v[80:83], v176 offset:6144
    ds_read_b128 v[84:87], v177 offset:6144
    v_exp_f32 v128, v128
    v_exp_f32 v129, v129
    v_exp_f32 v130, v130
    v_exp_f32 v131, v131
    v_mfma_f32_32x32x16_bf16 v[16:31], v[68:71], v[116:119], v[16:31]
    ds_read_b64_tr_b16 v[64:65], v178 offset:6144
    ds_read_b64_tr_b16 v[66:67], v178 offset:6528
    ds_read_b64_tr_b16 v[68:69], v178 offset:6912
    ds_read_b64_tr_b16 v[70:71], v178 offset:7296
    s_waitcnt lgkmcnt(4)
    v_mfma_f32_32x32x16_bf16 v[112:127], v[80:83], v[96:99], 0
    v_exp_f32 v132, v132
    v_exp_f32 v133, v133
    v_exp_f32 v134, v134
    v_exp_f32 v135, v135
    v_cvt_pk_bf16_f32 v128, v128, v129
    v_cvt_pk_bf16_f32 v129, v130, v131
    v_exp_f32 v136, v136
    v_exp_f32 v137, v137
    v_exp_f32 v138, v138
    v_exp_f32 v139, v139
    v_mfma_f32_32x32x16_bf16 v[112:127], v[84:87], v[100:103], v[112:127]
    v_cvt_pk_bf16_f32 v130, v132, v133
    v_cvt_pk_bf16_f32 v131, v134, v135
    v_exp_f32 v140, v140
    v_exp_f32 v141, v141
    v_exp_f32 v142, v142
    v_exp_f32 v143, v143
    v_mfma_f32_32x32x16_bf16 v[16:31], v[72:75], v[128:131], v[16:31]
    v_cvt_pk_bf16_f32 v132, v136, v137
    v_cvt_pk_bf16_f32 v133, v138, v139
    v_cvt_pk_bf16_f32 v134, v140, v141
    v_cvt_pk_bf16_f32 v135, v142, v143
    s_cmp_lg_u32 s43, 4
    s_cbranch_scc1 AT_SY_118
    s_add_u32 s62, s42, 1
    s_lshr_b32 s62, s62, 1
    v_mov_b32 v11, 52232
    s_mov_b32 s60, 0
CW_119:
    ds_read_b32 v12, v11
    s_waitcnt lgkmcnt(0)
    v_readfirstlane_b32 s61, v12
    s_nop 3
    s_cmp_ge_u32 s61, s62
    s_cbranch_scc1 CWD_120
    s_sleep 1
    s_add_u32 s60, s60, 1
    s_cmp_lt_u32 s60, 0x200000
    s_cbranch_scc1 CW_119
CWD_120:
    v_and_b32 v11, 15, v1
    v_lshlrev_b32 v11, 2, v11
    ds_read_b32 v12, v11 offset:51200
    s_waitcnt lgkmcnt(0)
    v_mov_b32_dpp v13, v12 row_ror:8 row_mask:0xf bank_mask:0xf
    v_max_f32 v12, v12, v13
    s_nop 1
    v_mov_b32_dpp v13, v12 row_ror:4 row_mask:0xf bank_mask:0xf
    v_max_f32 v12, v12, v13
    s_nop 1
    v_mov_b32_dpp v13, v12 row_ror:2 row_mask:0xf bank_mask:0xf
    v_max_f32 v12, v12, v13
    s_nop 1
    v_mov_b32_dpp v13, v12 row_ror:1 row_mask:0xf bank_mask:0xf
    v_max_f32 v12, v12, v13
    v_mul_f32 v12, v104, v12
    s_mov_b32 s50, 0x45440000
    v_mov_b32 v13, s50
    v_cmp_nle_f32 vcc, v12, v13
    s_nop 3
    s_cmp_lg_u64 vcc, 0
    s_cbranch_scc1 AT_FB2_84
AT_SY_118:
    s_cmp_lt_u32 s38, 6
    s_cbranch_scc1 W_121
    s_call_b64 s[88:89], SUB_IMPORT2
W_121:
    s_cmp_lt_u32 s38, 4
    s_cbranch_scc1 W_122
    s_setprio 0
W_122:
    s_cmp_lg_u32 s43, 0
    s_cbranch_scc1 AT_SYB_123
    s_add_u32 s62, s42, 1
    v_mov_b32 v11, 52236
    s_mov_b32 s60, 0
CW_124:
    ds_read_b32 v12, v11
    s_waitcnt lgkmcnt(0)
    v_readfirstlane_b32 s61, v12
    s_nop 3
    s_cmp_ge_u32 s61, s62
    s_cbranch_scc1 CWD_125
    s_sleep 1
    s_add_u32 s60, s60, 1
    s_cmp_lt_u32 s60, 0x200000
    s_cbranch_scc1 CW_124
CWD_125:
    v_and_b32 v11, 15, v1
    v_lshlrev_b32 v11, 2, v11
    ds_read_b32 v12, v11 offset:51200
    s_waitcnt lgkmcnt(0)
    v_mov_b32_dpp v13, v12 row_ror:8 row_mask:0xf bank_mask:0xf
    v_max_f32 v12, v12, v13
    s_nop 1
    v_mov_b32_dpp v13, v12 row_ror:4 row_mask:0xf bank_mask:0xf
    v_max_f32 v12, v12, v13
    s_nop 1
    v_mov_b32_dpp v13, v12 row_ror:2 row_mask:0xf bank_mask:0xf
    v_max_f32 v12, v12, v13
    s_nop 1
    v_mov_b32_dpp v13, v12 row_ror:1 row_mask:0xf bank_mask:0xf
    v_max_f32 v12, v12, v13
    v_mul_f32 v12, v104, v12
    s_mov_b32 s50, 0x45440000
    v_mov_b32 v13, s50
    v_cmp_nle_f32 vcc, v12, v13
    s_nop 3
    s_cmp_lg_u64 vcc, 0
    s_cbranch_scc1 AT_FB3_85
AT_SYB_123:
    ds_read_b128 v[88:91], v176 offset:4608
    ds_read_b128 v[92:95], v177 offset:4608
    v_exp_f32 v112, v112
    v_exp_f32 v113, v113
    v_exp_f32 v114, v114
    v_exp_f32 v115, v115
    v_mfma_f32_32x32x16_bf16 v[16:31], v[76:79], v[132:135], v[16:31]
    ds_read_b64_tr_b16 v[72:73], v178 offset:4608
    ds_read_b64_tr_b16 v[74:75], v178 offset:4992
    ds_read_b64_tr_b16 v[76:77], v178 offset:5376
    ds_read_b64_tr_b16 v[78:79], v178 offset:5760
    s_waitcnt lgkmcnt(4)
    v_mfma_f32_32x32x16_bf16 v[128:143], v[88:91], v[96:99], 0
    v_exp_f32 v116, v116
    v_exp_f32 v117, v117
    v_exp_f32 v118, v118
    v_exp_f32 v119, v119
    v_cvt_pk_bf16_f32 v112, v112, v113
    v_cvt_pk_bf16_f32 v113, v114, v115
    v_exp_f32 v120, v120
    v_exp_f32 v121, v121
    v_exp_f32 v122, v122
    v_exp_f32 v123, v123
    v_mfma_f32_32x32x16_bf16 v[128:143], v[92:95], v[100:103], v[128:143]
    v_cvt_pk_bf16_f32 v114, v116, v117
    v_cvt_pk_bf16_f32 v115, v118, v119
    v_exp_f32 v124, v124
    v_exp_f32 v125, v125
    v_exp_f32 v126, v126
    v_exp_f32 v127, v127
    v_mfma_f32_32x32x16_bf16 v[16:31], v[64:67], v[112:115], v[16:31]
    v_cvt_pk_bf16_f32 v116, v120, v121
    v_cvt_pk_bf16_f32 v117, v122, v123
    v_cvt_pk_bf16_f32 v118, v124, v125
    v_cvt_pk_bf16_f32 v119, v126, v127
    s_cmp_lg_u32 s43, 5
    s_cbranch_scc1 AT_SY_126
    s_add_u32 s62, s42, 1
    s_lshr_b32 s62, s62, 1
    v_mov_b32 v11, 52232
    s_mov_b32 s60, 0
CW_127:
    ds_read_b32 v12, v11
    s_waitcnt lgkmcnt(0)
    v_readfirstlane_b32 s61, v12
    s_nop 3
    s_cmp_ge_u32 s61, s62
    s_cbranch_scc1 CWD_128
    s_sleep 1
    s_add_u32 s60, s60, 1
    s_cmp_lt_u32 s60, 0x200000
    s_cbranch_scc1 CW_127
CWD_128:
    v_and_b32 v11, 15, v1
    v_lshlrev_b32 v11, 2, v11
    ds_read_b32 v12, v11 offset:51200
    s_waitcnt lgkmcnt(0)
    v_mov_b32_dpp v13, v12 row_ror:8 row_mask:0xf bank_mask:0xf
    v_max_f32 v12, v12, v13
    s_nop 1
    v_mov_b32_dpp v13, v12 row_ror:4 row_mask:0xf bank_mask:0xf
    v_max_f32 v12, v12, v13
    s_nop 1
    v_mov_b32_dpp v13, v12 row_ror:2 row_mask:0xf bank_mask:0xf
    v_max_f32 v12, v12, v13
    s_nop 1
    v_mov_b32_dpp v13, v12 row_ror:1 row_mask:0xf bank_mask:0xf
    v_max_f32 v12, v12, v13
    v_mul_f32 v12, v104, v12
    s_mov_b32 s50, 0x45440000
    v_mov_b32 v13, s50
    v_cmp_nle_f32 vcc, v12, v13
    s_nop 3
    s_cmp_lg_u64 vcc, 0
    s_cbranch_scc1 AT_FB2_84
AT_SY_126:
    s_cmp_lg_u32 s43, 1
    s_cbranch_scc1 AT_SYB_129
    s_add_u32 s62, s42, 1
    v_mov_b32 v11, 52236
    s_mov_b32 s60, 0
CW_130:
    ds_read_b32 v12, v11
    s_waitcnt lgkmcnt(0)
    v_readfirstlane_b32 s61, v12
    s_nop 3
    s_cmp_ge_u32 s61, s62
    s_cbranch_scc1 CWD_131
    s_sleep 1
    s_add_u32 s60, s60, 1
    s_cmp_lt_u32 s60, 0x200000
    s_cbranch_scc1 CW_130
CWD_131:
    v_and_b32 v11, 15, v1
    v_lshlrev_b32 v11, 2, v11
    ds_read_b32 v12, v11 offset:51200
    s_waitcnt lgkmcnt(0)
    v_mov_b32_dpp v13, v12 row_ror:8 row_mask:0xf bank_mask:0xf
    v_max_f32 v12, v12, v13
    s_nop 1
    v_mov_b32_dpp v13, v12 row_ror:4 row_mask:0xf bank_mask:0xf
    v_max_f32 v12, v12, v13
    s_nop 1
    v_mov_b32_dpp v13, v12 row_ror:2 row_mask:0xf bank_mask:0xf
    v_max_f32 v12, v12, v13
    s_nop 1
    v_mov_b32_dpp v13, v12 row_ror:1 row_mask:0xf bank_mask:0xf
    v_max_f32 v12, v12, v13
    v_mul_f32 v12, v104, v12
    s_mov_b32 s50, 0x45440000
    v_mov_b32 v13, s50
    v_cmp_nle_f32 vcc, v12, v13
    s_nop 3
    s_cmp_lg_u64 vcc, 0
    s_cbranch_scc1 AT_FB3_85
AT_SYB_129:
    ds_read_b128 v[80:83], v176 offset:3072
    ds_read_b128 v[84:87], v177 offset:3072
    v_exp_f32 v128, v128
    v_exp_f32 v129, v129
    v_exp_f32 v130, v130
    v_exp_f32 v131, v131
    v_mfma_f32_32x32x16_bf16 v[16:31], v[68:71], v[116:119], v[16:31]
    ds_read_b64_tr_b16 v[64:65], v178 offset:3072
    ds_read_b64_tr_b16 v[66:67], v178 offset:3456
    ds_read_b64_tr_b16 v[68:69], v178 offset:3840
    ds_read_b64_tr_b16 v[70:71], v178 offset:4224
    s_waitcnt lgkmcnt(4)
    v_mfma_f32_32x32x16_bf16 v[112:127], v[80:83], v[96:99], 0
    v_exp_f32 v132, v132
    v_exp_f32 v133, v133
    v_exp_f32 v134, v134
    v_exp_f32 v135, v135
    v_sub_f32 v48, 0xf149f2ca, v32
    v_sub_f32 v49, 0xf149f2ca, v33
    v_sub_f32 v50, 0xf149f2ca, v34
    v_sub_f32 v51, 0xf149f2ca, v35
    v_sub_f32 v52, 0xf149f2ca, v36
    v_sub_f32 v53, 0xf149f2ca, v37
    v_sub_f32 v54, 0xf149f2ca, v38
    v_sub_f32 v55, 0xf149f2ca, v39
    v_cvt_pk_bf16_f32 v128, v128, v129
    v_cvt_pk_bf16_f32 v129, v130, v131
    v_exp_f32 v136, v136
    v_exp_f32 v137, v137
    v_exp_f32 v138, v138
    v_exp_f32 v139, v139
    v_mfma_f32_32x32x16_bf16 v[112:127], v[84:87], v[100:103], v[112:127]
    v_cvt_pk_bf16_f32 v130, v132, v133
    v_cvt_pk_bf16_f32 v131, v134, v135
    v_exp_f32 v140, v140
    v_exp_f32 v141, v141
    v_exp_f32 v142, v142
    v_exp_f32 v143, v143
    v_mfma_f32_32x32x16_bf16 v[16:31], v[72:75], v[128:131], v[16:31]
    v_cvt_pk_bf16_f32 v132, v136, v137
    v_cvt_pk_bf16_f32 v133, v138, v139
    v_cvt_pk_bf16_f32 v134, v140, v141
    v_cvt_pk_bf16_f32 v135, v142, v143
    s_cmp_lg_u32 s43, 6
    s_cbranch_scc1 AT_SY_132
    s_add_u32 s62, s42, 1
    s_lshr_b32 s62, s62, 1
    v_mov_b32 v11, 52232
    s_mov_b32 s60, 0
CW_133:
    ds_read_b32 v12, v11
    s_waitcnt lgkmcnt(0)
    v_readfirstlane_b32 s61, v12
    s_nop 3
    s_cmp_ge_u32 s61, s62
    s_cbranch_scc1 CWD_134
    s_sleep 1
    s_add_u32 s60, s60, 1
    s_cmp_lt_u32 s60, 0x200000
    s_cbranch_scc1 CW_133
CWD_134:
    v_and_b32 v11, 15, v1
    v_lshlrev_b32 v11, 2, v11
    ds_read_b32 v12, v11 offset:51200
    s_waitcnt lgkmcnt(0)
    v_mov_b32_dpp v13, v12 row_ror:8 row_mask:0xf bank_mask:0xf
    v_max_f32 v12, v12, v13
    s_nop 1
    v_mov_b32_dpp v13, v12 row_ror:4 row_mask:0xf bank_mask:0xf
    v_max_f32 v12, v12, v13
    s_nop 1
    v_mov_b32_dpp v13, v12 row_ror:2 row_mask:0xf bank_mask:0xf
    v_max_f32 v12, v12, v13
    s_nop 1
    v_mov_b32_dpp v13, v12 row_ror:1 row_mask:0xf bank_mask:0xf
    v_max_f32 v12, v12, v13
    v_mul_f32 v12, v104, v12
    s_mov_b32 s50, 0x45440000
    v_mov_b32 v13, s50
    v_cmp_nle_f32 vcc, v12, v13
    s_nop 3
    s_cmp_lg_u64 vcc, 0
    s_cbranch_scc1 AT_FB2_84
AT_SY_132:
    s_cmp_lg_u32 s43, 2
    s_cbranch_scc1 AT_SYB_135
    s_add_u32 s62, s42, 1
    v_mov_b32 v11, 52236
    s_mov_b32 s60, 0
CW_136:
    ds_read_b32 v12, v11
    s_waitcnt lgkmcnt(0)
    v_readfirstlane_b32 s61, v12
    s_nop 3
    s_cmp_ge_u32 s61, s62
    s_cbranch_scc1 CWD_137
    s_sleep 1
    s_add_u32 s60, s60, 1
    s_cmp_lt_u32 s60, 0x200000
    s_cbranch_scc1 CW_136
CWD_137:
    v_and_b32 v11, 15, v1
    v_lshlrev_b32 v11, 2, v11
    ds_read_b32 v12, v11 offset:51200
    s_waitcnt lgkmcnt(0)
    v_mov_b32_dpp v13, v12 row_ror:8 row_mask:0xf bank_mask:0xf
    v_max_f32 v12, v12, v13
    s_nop 1
    v_mov_b32_dpp v13, v12 row_ror:4 row_mask:0xf bank_mask:0xf
    v_max_f32 v12, v12, v13
    s_nop 1
    v_mov_b32_dpp v13, v12 row_ror:2 row_mask:0xf bank_mask:0xf
    v_max_f32 v12, v12, v13
    s_nop 1
    v_mov_b32_dpp v13, v12 row_ror:1 row_mask:0xf bank_mask:0xf
    v_max_f32 v12, v12, v13
    v_mul_f32 v12, v104, v12
    s_mov_b32 s50, 0x45440000
    v_mov_b32 v13, s50
    v_cmp_nle_f32 vcc, v12, v13
    s_nop 3
    s_cmp_lg_u64 vcc, 0
    s_cbranch_scc1 AT_FB3_85
AT_SYB_135:
    ds_read_b128 v[88:91], v176 offset:1536
    ds_read_b128 v[92:95], v177 offset:1536
    v_exp_f32 v112, v112
    v_exp_f32 v113, v113
    v_exp_f32 v114, v114
    v_exp_f32 v115, v115
    v_mfma_f32_32x32x16_bf16 v[16:31], v[76:79], v[132:135], v[16:31]
    ds_read_b64_tr_b16 v[72:73], v178 offset:1536
    ds_read_b64_tr_b16 v[74:75], v178 offset:1920
    ds_read_b64_tr_b16 v[76:77], v178 offset:2304
    ds_read_b64_tr_b16 v[78:79], v178 offset:2688
    s_waitcnt lgkmcnt(4)
    v_mfma_f32_32x32x16_bf16 v[128:143], v[88:91], v[96:99], 0
    v_exp_f32 v116, v116
    v_exp_f32 v117, v117
    v_exp_f32 v118, v118
    v_exp_f32 v119, v119
    v_sub_f32 v56, 0xf149f2ca, v40
    v_sub_f32 v57, 0xf149f2ca, v41
    v_sub_f32 v58, 0xf149f2ca, v42
    v_sub_f32 v59, 0xf149f2ca, v43
    v_sub_f32 v60, 0xf149f2ca, v44
    v_sub_f32 v61, 0xf149f2ca, v45
    v_sub_f32 v62, 0xf149f2ca, v46
    v_sub_f32 v63, 0xf149f2ca, v47
    v_cvt_pk_bf16_f32 v112, v112, v113
    v_cvt_pk_bf16_f32 v113, v114, v115
    v_exp_f32 v120, v120
    v_exp_f32 v121, v121
    v_exp_f32 v122, v122
    v_exp_f32 v123, v123
    v_mfma_f32_32x32x16_bf16 v[128:143], v[92:95], v[100:103], v[128:143]
    v_cvt_pk_bf16_f32 v114, v116, v117
    v_cvt_pk_bf16_f32 v115, v118, v119
    v_exp_f32 v124, v124
    v_exp_f32 v125, v125
    v_exp_f32 v126, v126
    v_exp_f32 v127, v127
    v_mfma_f32_32x32x16_bf16 v[16:31], v[64:67], v[112:115], v[16:31]
    v_cvt_pk_bf16_f32 v116, v120, v121
    v_cvt_pk_bf16_f32 v117, v122, v123
    v_cvt_pk_bf16_f32 v118, v124, v125
    v_cvt_pk_bf16_f32 v119, v126, v127
    s_cmp_lg_u32 s43, 7
    s_cbranch_scc1 AT_SY_138
    s_add_u32 s62, s42, 1
    s_lshr_b32 s62, s62, 1
    v_mov_b32 v11, 52232
    s_mov_b32 s60, 0
CW_139:
    ds_read_b32 v12, v11
    s_waitcnt lgkmcnt(0)
    v_readfirstlane_b32 s61, v12
    s_nop 3
    s_cmp_ge_u32 s61, s62
    s_cbranch_scc1 CWD_140
    s_sleep 1
    s_add_u32 s60, s60, 1
    s_cmp_lt_u32 s60, 0x200000
    s_cbranch_scc1 CW_139
CWD_140:
    v_and_b32 v11, 15, v1
    v_lshlrev_b32 v11, 2, v11
    ds_read_b32 v12, v11 offset:51200
    s_waitcnt lgkmcnt(0)
    v_mov_b32_dpp v13, v12 row_ror:8 row_mask:0xf bank_mask:0xf
    v_max_f32 v12, v12, v13
    s_nop 1
    v_mov_b32_dpp v13, v12 row_ror:4 row_mask:0xf bank_mask:0xf
    v_max_f32 v12, v12, v13
    s_nop 1
    v_mov_b32_dpp v13, v12 row_ror:2 row_mask:0xf bank_mask:0xf
    v_max_f32 v12, v12, v13
    s_nop 1
    v_mov_b32_dpp v13, v12 row_ror:1 row_mask:0xf bank_mask:0xf
    v_max_f32 v12, v12, v13
    v_mul_f32 v12, v104, v12
    s_mov_b32 s50, 0x45440000
    v_mov_b32 v13, s50
    v_cmp_nle_f32 vcc, v12, v13
    s_nop 3
    s_cmp_lg_u64 vcc, 0
    s_cbranch_scc1 AT_FB2_84
AT_SY_138:
    s_cmp_lg_u32 s43, 3
    s_cbranch_scc1 AT_SYB_141
    s_add_u32 s62, s42, 1
    v_mov_b32 v11, 52236
    s_mov_b32 s60, 0
CW_142:
    ds_read_b32 v12, v11
    s_waitcnt lgkmcnt(0)
    v_readfirstlane_b32 s61, v12
    s_nop 3
    s_cmp_ge_u32 s61, s62
    s_cbranch_scc1 CWD_143
    s_sleep 1
    s_add_u32 s60, s60, 1
    s_cmp_lt_u32 s60, 0x200000
    s_cbranch_scc1 CW_142
CWD_143:
    v_and_b32 v11, 15, v1
    v_lshlrev_b32 v11, 2, v11
    ds_read_b32 v12, v11 offset:51200
    s_waitcnt lgkmcnt(0)
    v_mov_b32_dpp v13, v12 row_ror:8 row_mask:0xf bank_mask:0xf
    v_max_f32 v12, v12, v13
    s_nop 1
    v_mov_b32_dpp v13, v12 row_ror:4 row_mask:0xf bank_mask:0xf
    v_max_f32 v12, v12, v13
    s_nop 1
    v_mov_b32_dpp v13, v12 row_ror:2 row_mask:0xf bank_mask:0xf
    v_max_f32 v12, v12, v13
    s_nop 1
    v_mov_b32_dpp v13, v12 row_ror:1 row_mask:0xf bank_mask:0xf
    v_max_f32 v12, v12, v13
    v_mul_f32 v12, v104, v12
    s_mov_b32 s50, 0x45440000
    v_mov_b32 v13, s50
    v_cmp_nle_f32 vcc, v12, v13
    s_nop 3
    s_cmp_lg_u64 vcc, 0
    s_cbranch_scc1 AT_FB3_85
AT_SYB_141:
    ds_read_b128 v[80:83], v176 offset:0
    ds_read_b128 v[84:87], v177 offset:0
    v_exp_f32 v128, v128
    v_exp_f32 v129, v129
    v_exp_f32 v130, v130
    v_exp_f32 v131, v131
    v_mfma_f32_32x32x16_bf16 v[16:31], v[68:71], v[116:119], v[16:31]
    ds_read_b64_tr_b16 v[64:65], v178 offset:0
    ds_read_b64_tr_b16 v[66:67], v178 offset:384
    ds_read_b64_tr_b16 v[68:69], v178 offset:768
    ds_read_b64_tr_b16 v[70:71], v178 offset:1152
    s_waitcnt lgkmcnt(4)
    v_mfma_f32_32x32x16_bf16 v[112:127], v[80:83], v[96:99], v[48:63]
    v_exp_f32 v132, v132
    v_exp_f32 v133, v133
    v_exp_f32 v134, v134
    v_exp_f32 v135, v135
    v_cvt_pk_bf16_f32 v128, v128, v129
    v_cvt_pk_bf16_f32 v129, v130, v131
    v_exp_f32 v136, v136
    v_exp_f32 v137, v137
    v_exp_f32 v138, v138
    v_exp_f32 v139, v139
    v_mfma_f32_32x32x16_bf16 v[112:127], v[84:87], v[100:103], v[112:127]
    v_cvt_pk_bf16_f32 v130, v132, v133
    v_cvt_pk_bf16_f32 v131, v134, v135
    v_exp_f32 v140, v140
    v_exp_f32 v141, v141
    v_exp_f32 v142, v142
    v_exp_f32 v143, v143
    v_mfma_f32_32x32x16_bf16 v[16:31], v[72:75], v[128:131], v[16:31]
    v_cvt_pk_bf16_f32 v132, v136, v137
    v_cvt_pk_bf16_f32 v133, v138, v139
    v_cvt_pk_bf16_f32 v134, v140, v141
    v_cvt_pk_bf16_f32 v135, v142, v143
    s_nop 0
    v_exp_f32 v112, v112
    v_exp_f32 v113, v113
    v_exp_f32 v114, v114
    v_exp_f32 v115, v115
    v_mfma_f32_32x32x16_bf16 v[16:31], v[76:79], v[132:135], v[16:31]
    v_exp_f32 v116, v116
    v_exp_f32 v117, v117
    v_exp_f32 v118, v118
    v_exp_f32 v119, v119
    v_cvt_pk_bf16_f32 v112, v112, v113
    v_cvt_pk_bf16_f32 v113, v114, v115
    v_exp_f32 v120, v120
    v_exp_f32 v121, v121
    v_exp_f32 v122, v122
    v_exp_f32 v123, v123
    v_cvt_pk_bf16_f32 v114, v116, v117
    v_cvt_pk_bf16_f32 v115, v118, v119
    s_waitcnt lgkmcnt(0)
    v_exp_f32 v124, v124
    v_exp_f32 v125, v125
    v_exp_f32 v126, v126
    v_exp_f32 v127, v127
    v_mfma_f32_32x32x16_bf16 v[16:31], v[64:67], v[112:115], v[16:31]
    v_cvt_pk_bf16_f32 v116, v120, v121
    v_cvt_pk_bf16_f32 v117, v122, v123
    v_cvt_pk_bf16_f32 v118, v124, v125
    v_cvt_pk_bf16_f32 v119, v126, v127
    s_nop 1
    v_mfma_f32_32x32x16_bf16 v[16:31], v[68:71], v[116:119], v[16:31]
    s_branch AT_DONE_86
AT_FB1_83:
    s_waitcnt lgkmcnt(0)
    s_cmp_lt_u32 s38, 4
    s_cbranch_scc1 W_144
    s_cmp_eq_u32 s36, 7
    s_cbranch_scc1 LF_E_145
    s_waitcnt vmcnt(0)
    s_lshl_b32 s53, s43, 2
    s_add_u32 s53, s53, 32
    s_add_u32 s54, s42, 1
    s_lshl_b32 s52, s2, 6
    s_add_u32 s52, s52, 16384
    s_add_u32 s52, s52, s53
    s_add_u32 s63, s93, s54
    v_mov_b32 v11, s63
    v_mov_b32 v12, 0
    s_mov_b64 exec, 1
    buffer_store_dword v11, v12, s[4:7], s52 offen sc1
    s_mov_b64 exec, -1
LF_E_145:
    s_cmp_lg_u32 s38, 4
    s_cbranch_scc1 W_146
    v_mov_b32 v11, 52224
    ds_read_b32 v12, v11 offset:16
    s_waitcnt lgkmcnt(0)
    v_readfirstlane_b32 s61, v12
    s_nop 3
    s_cmp_eq_u32 s61, 0
    s_cbranch_scc1 S1_D_147
    s_call_b64 s[88:89], SUB_IMPORT1
S1_D_147:
W_146:
W_144:
    s_add_u32 s62, s42, 1
    s_lshr_b32 s62, s62, 1
    v_mov_b32 v11, 52232
    s_mov_b32 s60, 0
CW_148:
    ds_read_b32 v12, v11
    s_waitcnt lgkmcnt(0)
    v_readfirstlane_b32 s61, v12
    s_nop 3
    s_cmp_ge_u32 s61, s62
    s_cbranch_scc1 CWD_149
    s_sleep 1
    s_add_u32 s60, s60, 1
    s_cmp_lt_u32 s60, 0x200000
    s_cbranch_scc1 CW_148
CWD_149:
AT_FB2_84:
    s_cmp_lt_u32 s38, 4
    s_cbranch_scc1 W_150
    s_cmp_lt_u32 s38, 6
    s_cbranch_scc1 W_151
    s_waitcnt vmcnt(0)
    s_mov_b32 s96, 1
    s_call_b64 s[88:89], SUB_IMPORT2
W_151:
    s_add_u32 s62, s42, 1
    v_mov_b32 v11, 52236
    s_mov_b32 s60, 0
CW_152:
    ds_read_b32 v12, v11
    s_waitcnt lgkmcnt(0)
    v_readfirstlane_b32 s61, v12
    s_nop 3
    s_cmp_ge_u32 s61, s62
    s_cbranch_scc1 CWD_153
    s_sleep 1
    s_add_u32 s60, s60, 1
    s_cmp_lt_u32 s60, 0x200000
    s_cbranch_scc1 CW_152
CWD_153:
W_150:
AT_FB3_85:
    s_setprio 0
    s_waitcnt vmcnt(0) lgkmcnt(0)
    v_sub_f32 v48, 0xf149f2ca, v32
    v_sub_f32 v49, 0xf149f2ca, v33
    v_sub_f32 v50, 0xf149f2ca, v34
    v_sub_f32 v51, 0xf149f2ca, v35
    v_sub_f32 v52, 0xf149f2ca, v36
    v_sub_f32 v53, 0xf149f2ca, v37
    v_sub_f32 v54, 0xf149f2ca, v38
    v_sub_f32 v55, 0xf149f2ca, v39
    v_sub_f32 v56, 0xf149f2ca, v40
    v_sub_f32 v57, 0xf149f2ca, v41
    v_sub_f32 v58, 0xf149f2ca, v42
    v_sub_f32 v59, 0xf149f2ca, v43
    v_sub_f32 v60, 0xf149f2ca, v44
    v_sub_f32 v61, 0xf149f2ca, v45
    v_sub_f32 v62, 0xf149f2ca, v46
    v_sub_f32 v63, 0xf149f2ca, v47
    v_mov_b32 v10, 0xff7fffff
    v_mov_b32 v11, 0xff7fffff
    ds_read_b128 v[80:83], v176 offset:12288
    ds_read_b128 v[84:87], v177 offset:12288
    ds_read_b128 v[88:91], v176 offset:10752
    ds_read_b128 v[92:95], v177 offset:10752
    s_waitcnt lgkmcnt(2)
    v_mfma_f32_32x32x16_bf16 v[112:127], v[80:83], v[96:99], v[32:47]
    v_mfma_f32_32x32x16_bf16 v[112:127], v[84:87], v[100:103], v[112:127]
    s_nop 11
    v_max3_f32 v10, v10, v112, v113
    v_max3_f32 v11, v11, v114, v115
    v_max3_f32 v10, v10, v116, v117
    v_max3_f32 v11, v11, v118, v119
    v_max3_f32 v10, v10, v120, v121
    v_max3_f32 v11, v11, v122, v123
    v_max3_f32 v10, v10, v124, v125
    v_max3_f32 v11, v11, v126, v127
    ds_read_b128 v[80:83], v176 offset:9216
    ds_read_b128 v[84:87], v177 offset:9216
    s_waitcnt lgkmcnt(2)
    v_mfma_f32_32x32x16_bf16 v[128:143], v[88:91], v[96:99], 0
    v_mfma_f32_32x32x16_bf16 v[128:143], v[92:95], v[100:103], v[128:143]
    s_nop 11
    v_max3_f32 v10, v10, v128, v129
    v_max3_f32 v11, v11, v130, v131
    v_max3_f32 v10, v10, v132, v133
    v_max3_f32 v11, v11, v134, v135
    v_max3_f32 v10, v10, v136, v137
    v_max3_f32 v11, v11, v138, v139
    v_max3_f32 v10, v10, v140, v141
    v_max3_f32 v11, v11, v142, v143
    ds_read_b128 v[88:91], v176 offset:7680
    ds_read_b128 v[92:95], v177 offset:7680
    s_waitcnt lgkmcnt(2)
    v_mfma_f32_32x32x16_bf16 v[112:127], v[80:83], v[96:99], 0
    v_mfma_f32_32x32x16_bf16 v[112:127], v[84:87], v[100:103], v[112:127]
    s_nop 11
    v_max3_f32 v10, v10, v112, v113
    v_max3_f32 v11, v11, v114, v115
    v_max3_f32 v10, v10, v116, v117
    v_max3_f32 v11, v11, v118, v119
    v_max3_f32 v10, v10, v120, v121
    v_max3_f32 v11, v11, v122, v123
    v_max3_f32 v10, v10, v124, v125
    v_max3_f32 v11, v11, v126, v127
    ds_read_b128 v[80:83], v176 offset:6144
    ds_read_b128 v[84:87], v177 offset:6144
    s_waitcnt lgkmcnt(2)
    v_mfma_f32_32x32x16_bf16 v[128:143], v[88:91], v[96:99], 0
    v_mfma_f32_32x32x16_bf16 v[128:143], v[92:95], v[100:103], v[128:143]
    s_nop 11
    v_max3_f32 v10, v10, v128, v129
    v_max3_f32 v11, v11, v130, v131
    v_max3_f32 v10, v10, v132, v133
    v_max3_f32 v11, v11, v134, v135
    v_max3_f32 v10, v10, v136, v137
    v_max3_f32 v11, v11, v138, v139
    v_max3_f32 v10, v10, v140, v141
    v_max3_f32 v11, v11, v142, v143
    ds_read_b128 v[88:91], v176 offset:4608
    ds_read_b128 v[92:95], v177 offset:4608
    s_waitcnt lgkmcnt(2)
    v_mfma_f32_32x32x16_bf16 v[112:127], v[80:83], v[96:99], 0
    v_mfma_f32_32x32x16_bf16 v[112:127], v[84:87], v[100:103], v[112:127]
    s_nop 11
    v_max3_f32 v10, v10, v112, v113
    v_max3_f32 v11, v11, v114, v115
    v_max3_f32 v10, v10, v116, v117
    v_max3_f32 v11, v11, v118, v119
    v_max3_f32 v10, v10, v120, v121
    v_max3_f32 v11, v11, v122, v123
    v_max3_f32 v10, v10, v124, v125
    v_max3_f32 v11, v11, v126, v127
    ds_read_b128 v[80:83], v176 offset:3072
    ds_read_b128 v[84:87], v177 offset:3072
    s_waitcnt lgkmcnt(2)
    v_mfma_f32_32x32x16_bf16 v[128:143], v[88:91], v[96:99], 0
    v_mfma_f32_32x32x16_bf16 v[128:143], v[92:95], v[100:103], v[128:143]
    s_nop 11
    v_max3_f32 v10, v10, v128, v129
    v_max3_f32 v11, v11, v130, v131
    v_max3_f32 v10, v10, v132, v133
    v_max3_f32 v11, v11, v134, v135
    v_max3_f32 v10, v10, v136, v137
    v_max3_f32 v11, v11, v138, v139
    v_max3_f32 v10, v10, v140, v141
    v_max3_f32 v11, v11, v142, v143
    ds_read_b128 v[88:91], v176 offset:1536
    ds_read_b128 v[92:95], v177 offset:1536
    s_waitcnt lgkmcnt(2)
    v_mfma_f32_32x32x16_bf16 v[112:127], v[80:83], v[96:99], 0
    v_mfma_f32_32x32x16_bf16 v[112:127], v[84:87], v[100:103], v[112:127]
    s_nop 11
    v_max3_f32 v10, v10, v112, v113
    v_max3_f32 v11, v11, v114, v115
    v_max3_f32 v10, v10, v116, v117
    v_max3_f32 v11, v11, v118, v119
    v_max3_f32 v10, v10, v120, v121
    v_max3_f32 v11, v11, v122, v123
    v_max3_f32 v10, v10, v124, v125
    v_max3_f32 v11, v11, v126, v127
    ds_read_b128 v[80:83], v176 offset:0
    ds_read_b128 v[84:87], v177 offset:0
    s_waitcnt lgkmcnt(2)
    v_mfma_f32_32x32x16_bf16 v[128:143], v[88:91], v[96:99], 0
    v_mfma_f32_32x32x16_bf16 v[128:143], v[92:95], v[100:103], v[128:143]
    s_nop 11
    v_max3_f32 v10, v10, v128, v129
    v_max3_f32 v11, v11, v130, v131
    v_max3_f32 v10, v10, v132, v133
    v_max3_f32 v11, v11, v134, v135
    v_max3_f32 v10, v10, v136, v137
    v_max3_f32 v11, v11, v138, v139
    v_max3_f32 v10, v10, v140, v141
    v_max3_f32 v11, v11, v142, v143
    s_waitcnt lgkmcnt(0)
    v_mfma_f32_32x32x16_bf16 v[112:127], v[80:83], v[96:99], v[48:63]
    v_mfma_f32_32x32x16_bf16 v[112:127], v[84:87], v[100:103], v[112:127]
    s_nop 11
    v_max3_f32 v10, v10, v112, v113
    v_max3_f32 v11, v11, v114, v115
    v_max3_f32 v10, v10, v116, v117
    v_max3_f32 v11, v11, v118, v119
    v_max3_f32 v10, v10, v120, v121
    v_max3_f32 v11, v11, v122, v123
    v_max3_f32 v10, v10, v124, v125
    v_max3_f32 v11, v11, v126, v127
    v_max_f32 v10, v10, v11
    v_mov_b32 v11, v10
    s_nop 1
    v_permlane32_swap_b32 v10, v11
    v_max_f32 v10, v10, v11
    v_sub_f32 v160, 0, v10
    v_sub_f32 v32, v32, v10
    v_sub_f32 v48, v48, v10
    v_sub_f32 v161, 0, v10
    v_sub_f32 v33, v33, v10
    v_sub_f32 v49, v49, v10
    v_sub_f32 v162, 0, v10
    v_sub_f32 v34, v34, v10
    v_sub_f32 v50, v50, v10
    v_sub_f32 v163, 0, v10
    v_sub_f32 v35, v35, v10
    v_sub_f32 v51, v51, v10
    v_sub_f32 v164, 0, v10
    v_sub_f32 v36, v36, v10
    v_sub_f32 v52, v52, v10
    v_sub_f32 v165, 0, v10
    v_sub_f32 v37, v37, v10
    v_sub_f32 v53, v53, v10
    v_sub_f32 v166, 0, v10
    v_sub_f32 v38, v38, v10
    v_sub_f32 v54, v54, v10
    v_sub_f32 v167, 0, v10
    v_sub_f32 v39, v39, v10
    v_sub_f32 v55, v55, v10
    v_sub_f32 v168, 0, v10
    v_sub_f32 v40, v40, v10
    v_sub_f32 v56, v56, v10
    v_sub_f32 v169, 0, v10
    v_sub_f32 v41, v41, v10
    v_sub_f32 v57, v57, v10
    v_sub_f32 v170, 0, v10
    v_sub_f32 v42, v42, v10
    v_sub_f32 v58, v58, v10
    v_sub_f32 v171, 0, v10
    v_sub_f32 v43, v43, v10
    v_sub_f32 v59, v59, v10
    v_sub_f32 v172, 0, v10
    v_sub_f32 v44, v44, v10
    v_sub_f32 v60, v60, v10
    v_sub_f32 v173, 0, v10
    v_sub_f32 v45, v45, v10
    v_sub_f32 v61, v61, v10
    v_sub_f32 v174, 0, v10
    v_sub_f32 v46, v46, v10
    v_sub_f32 v62, v62, v10
    v_sub_f32 v175, 0, v10
    v_sub_f32 v47, v47, v10
    v_sub_f32 v63, v63, v10
    ds_read_b128 v[80:83], v176 offset:12288
    ds_read_b128 v[84:87], v177 offset:12288
    ds_read_b64_tr_b16 v[64:65], v178 offset:12288
    ds_read_b64_tr_b16 v[66:67], v178 offset:12672
    ds_read_b64_tr_b16 v[68:69], v178 offset:13056
    ds_read_b64_tr_b16 v[70:71], v178 offset:13440
    s_waitcnt lgkmcnt(4)
    v_mfma_f32_32x32x16_bf16 v[112:127], v[80:83], v[96:99], v[32:47]
    v_mfma_f32_32x32x16_bf16 v[112:127], v[84:87], v[100:103], v[112:127]
    ds_read_b128 v[88:91], v176 offset:10752
    ds_read_b128 v[92:95], v177 offset:10752
    s_nop 9
    v_exp_f32 v112, v112
    v_exp_f32 v113, v113
    v_exp_f32 v114, v114
    v_exp_f32 v115, v115
    ds_read_b64_tr_b16 v[72:73], v178 offset:10752
    ds_read_b64_tr_b16 v[74:75], v178 offset:11136
    ds_read_b64_tr_b16 v[76:77], v178 offset:11520
    ds_read_b64_tr_b16 v[78:79], v178 offset:11904
    s_waitcnt lgkmcnt(4)
    v_mfma_f32_32x32x16_bf16 v[128:143], v[88:91], v[96:99], v[160:175]
    v_exp_f32 v116, v116
    v_exp_f32 v117, v117
    v_exp_f32 v118, v118
    v_exp_f32 v119, v119
    v_cvt_pk_bf16_f32 v112, v112, v113
    v_cvt_pk_bf16_f32 v113, v114, v115
    v_exp_f32 v120, v120
    v_exp_f32 v121, v121
    v_exp_f32 v122, v122
    v_exp_f32 v123, v123
    v_mfma_f32_32x32x16_bf16 v[128:143], v[92:95], v[100:103], v[128:143]
    v_cvt_pk_bf16_f32 v114, v116, v117
    v_cvt_pk_bf16_f32 v115, v118, v119
    v_exp_f32 v124, v124
    v_exp_f32 v125, v125
    v_exp_f32 v126, v126
    v_exp_f32 v127, v127
    v_mfma_f32_32x32x16_bf16 v[16:31], v[64:67], v[112:115], 0
    v_cvt_pk_bf16_f32 v116, v120, v121
    v_cvt_pk_bf16_f32 v117, v122, v123
    v_cvt_pk_bf16_f32 v118, v124, v125
    v_cvt_pk_bf16_f32 v119, v126, v127
    ds_read_b128 v[80:83], v176 offset:9216
    ds_read_b128 v[84:87], v177 offset:9216
    v_exp_f32 v128, v128
    v_exp_f32 v129, v129
    v_exp_f32 v130, v130
    v_exp_f32 v131, v131
    v_mfma_f32_32x32x16_bf16 v[16:31], v[68:71], v[116:119], v[16:31]
    ds_read_b64_tr_b16 v[64:65], v178 offset:9216
    ds_read_b64_tr_b16 v[66:67], v178 offset:9600
    ds_read_b64_tr_b16 v[68:69], v178 offset:9984
    ds_read_b64_tr_b16 v[70:71], v178 offset:10368
    s_waitcnt lgkmcnt(4)
    v_mfma_f32_32x32x16_bf16 v[112:127], v[80:83], v[96:99], v[160:175]
    v_exp_f32 v132, v132
    v_exp_f32 v133, v133
    v_exp_f32 v134, v134
    v_exp_f32 v135, v135
    v_cvt_pk_bf16_f32 v128, v128, v129
    v_cvt_pk_bf16_f32 v129, v130, v131
    v_exp_f32 v136, v136
    v_exp_f32 v137, v137
    v_exp_f32 v138, v138
    v_exp_f32 v139, v139
    v_mfma_f32_32x32x16_bf16 v[112:127], v[84:87], v[100:103], v[112:127]
    v_cvt_pk_bf16_f32 v130, v132, v133
    v_cvt_pk_bf16_f32 v131, v134, v135
    v_exp_f32 v140, v140
    v_exp_f32 v141, v141
    v_exp_f32 v142, v142
    v_exp_f32 v143, v143
    v_mfma_f32_32x32x16_bf16 v[16:31], v[72:75], v[128:131], v[16:31]
    v_cvt_pk_bf16_f32 v132, v136, v137
    v_cvt_pk_bf16_f32 v133, v138, v139
    v_cvt_pk_bf16_f32 v134, v140, v141
    v_cvt_pk_bf16_f32 v135, v142, v143
    ds_read_b128 v[88:91], v176 offset:7680
    ds_read_b128 v[92:95], v177 offset:7680
    v_exp_f32 v112, v112
    v_exp_f32 v113, v113
    v_exp_f32 v114, v114
    v_exp_f32 v115, v115
    v_mfma_f32_32x32x16_bf16 v[16:31], v[76:79], v[132:135], v[16:31]
    ds_read_b64_tr_b16 v[72:73], v178 offset:7680
    ds_read_b64_tr_b16 v[74:75], v178 offset:8064
    ds_read_b64_tr_b16 v[76:77], v178 offset:8448
    ds_read_b64_tr_b16 v[78:79], v178 offset:8832
    s_waitcnt lgkmcnt(4)
    v_mfma_f32_32x32x16_bf16 v[128:143], v[88:91], v[96:99], v[160:175]
    v_exp_f32 v116, v116
    v_exp_f32 v117, v117
    v_exp_f32 v118, v118
    v_exp_f32 v119, v119
    v_cvt_pk_bf16_f32 v112, v112, v113
    v_cvt_pk_bf16_f32 v113, v114, v115
    v_exp_f32 v120, v120
    v_exp_f32 v121, v121
    v_exp_f32 v122, v122
    v_exp_f32 v123, v123
    v_mfma_f32_32x32x16_bf16 v[128:143], v[92:95], v[100:103], v[128:143]
    v_cvt_pk_bf16_f32 v114, v116, v117
    v_cvt_pk_bf16_f32 v115, v118, v119
    v_exp_f32 v124, v124
    v_exp_f32 v125, v125
    v_exp_f32 v126, v126
    v_exp_f32 v127, v127
    v_mfma_f32_32x32x16_bf16 v[16:31], v[64:67], v[112:115], v[16:31]
    v_cvt_pk_bf16_f32 v116, v120, v121
    v_cvt_pk_bf16_f32 v117, v122, v123
    v_cvt_pk_bf16_f32 v118, v124, v125
    v_cvt_pk_bf16_f32 v119, v126, v127
    ds_read_b128 v[80:83], v176 offset:6144
    ds_read_b128 v[84:87], v177 offset:6144
    v_exp_f32 v128, v128
    v_exp_f32 v129, v129
    v_exp_f32 v130, v130
    v_exp_f32 v131, v131
    v_mfma_f32_32x32x16_bf16 v[16:31], v[68:71], v[116:119], v[16:31]
    ds_read_b64_tr_b16 v[64:65], v178 offset:6144
    ds_read_b64_tr_b16 v[66:67], v178 offset:6528
    ds_read_b64_tr_b16 v[68:69], v178 offset:6912
    ds_read_b64_tr_b16 v[70:71], v178 offset:7296
    s_waitcnt lgkmcnt(4)
    v_mfma_f32_32x32x16_bf16 v[112:127], v[80:83], v[96:99], v[160:175]
    v_exp_f32 v132, v132
    v_exp_f32 v133, v133
    v_exp_f32 v134, v134
    v_exp_f32 v135, v135
    v_cvt_pk_bf16_f32 v128, v128, v129
    v_cvt_pk_bf16_f32 v129, v130, v131
    v_exp_f32 v136, v136
    v_exp_f32 v137, v137
    v_exp_f32 v138, v138
    v_exp_f32 v139, v139
    v_mfma_f32_32x32x16_bf16 v[112:127], v[84:87], v[100:103], v[112:127]
    v_cvt_pk_bf16_f32 v130, v132, v133
    v_cvt_pk_bf16_f32 v131, v134, v135
    v_exp_f32 v140, v140
    v_exp_f32 v141, v141
    v_exp_f32 v142, v142
    v_exp_f32 v143, v143
    v_mfma_f32_32x32x16_bf16 v[16:31], v[72:75], v[128:131], v[16:31]
    v_cvt_pk_bf16_f32 v132, v136, v137
    v_cvt_pk_bf16_f32 v133, v138, v139
    v_cvt_pk_bf16_f32 v134, v140, v141
    v_cvt_pk_bf16_f32 v135, v142, v143
    ds_read_b128 v[88:91], v176 offset:4608
    ds_read_b128 v[92:95], v177 offset:4608
    v_exp_f32 v112, v112
    v_exp_f32 v113, v113
    v_exp_f32 v114, v114
    v_exp_f32 v115, v115
    v_mfma_f32_32x32x16_bf16 v[16:31], v[76:79], v[132:135], v[16:31]
    ds_read_b64_tr_b16 v[72:73], v178 offset:4608
    ds_read_b64_tr_b16 v[74:75], v178 offset:4992
    ds_read_b64_tr_b16 v[76:77], v178 offset:5376
    ds_read_b64_tr_b16 v[78:79], v178 offset:5760
    s_waitcnt lgkmcnt(4)
    v_mfma_f32_32x32x16_bf16 v[128:143], v[88:91], v[96:99], v[160:175]
    v_exp_f32 v116, v116
    v_exp_f32 v117, v117
    v_exp_f32 v118, v118
    v_exp_f32 v119, v119
    v_cvt_pk_bf16_f32 v112, v112, v113
    v_cvt_pk_bf16_f32 v113, v114, v115
    v_exp_f32 v120, v120
    v_exp_f32 v121, v121
    v_exp_f32 v122, v122
    v_exp_f32 v123, v123
    v_mfma_f32_32x32x16_bf16 v[128:143], v[92:95], v[100:103], v[128:143]
    v_cvt_pk_bf16_f32 v114, v116, v117
    v_cvt_pk_bf16_f32 v115, v118, v119
    v_exp_f32 v124, v124
    v_exp_f32 v125, v125
    v_exp_f32 v126, v126
    v_exp_f32 v127, v127
    v_mfma_f32_32x32x16_bf16 v[16:31], v[64:67], v[112:115], v[16:31]
    v_cvt_pk_bf16_f32 v116, v120, v121
    v_cvt_pk_bf16_f32 v117, v122, v123
    v_cvt_pk_bf16_f32 v118, v124, v125
    v_cvt_pk_bf16_f32 v119, v126, v127
    ds_read_b128 v[80:83], v176 offset:3072
    ds_read_b128 v[84:87], v177 offset:3072
    v_exp_f32 v128, v128
    v_exp_f32 v129, v129
    v_exp_f32 v130, v130
    v_exp_f32 v131, v131
    v_mfma_f32_32x32x16_bf16 v[16:31], v[68:71], v[116:119], v[16:31]
    ds_read_b64_tr_b16 v[64:65], v178 offset:3072
    ds_read_b64_tr_b16 v[66:67], v178 offset:3456
    ds_read_b64_tr_b16 v[68:69], v178 offset:3840
    ds_read_b64_tr_b16 v[70:71], v178 offset:4224
    s_waitcnt lgkmcnt(4)
    v_mfma_f32_32x32x16_bf16 v[112:127], v[80:83], v[96:99], v[160:175]
    v_exp_f32 v132, v132
    v_exp_f32 v133, v133
    v_exp_f32 v134, v134
    v_exp_f32 v135, v135
    v_cvt_pk_bf16_f32 v128, v128, v129
    v_cvt_pk_bf16_f32 v129, v130, v131
    v_exp_f32 v136, v136
    v_exp_f32 v137, v137
    v_exp_f32 v138, v138
    v_exp_f32 v139, v139
    v_mfma_f32_32x32x16_bf16 v[112:127], v[84:87], v[100:103], v[112:127]
    v_cvt_pk_bf16_f32 v130, v132, v133
    v_cvt_pk_bf16_f32 v131, v134, v135
    v_exp_f32 v140, v140
    v_exp_f32 v141, v141
    v_exp_f32 v142, v142
    v_exp_f32 v143, v143
    v_mfma_f32_32x32x16_bf16 v[16:31], v[72:75], v[128:131], v[16:31]
    v_cvt_pk_bf16_f32 v132, v136, v137
    v_cvt_pk_bf16_f32 v133, v138, v139
    v_cvt_pk_bf16_f32 v134, v140, v141
    v_cvt_pk_bf16_f32 v135, v142, v143
    ds_read_b128 v[88:91], v176 offset:1536
    ds_read_b128 v[92:95], v177 offset:1536
    v_exp_f32 v112, v112
    v_exp_f32 v113, v113
    v_exp_f32 v114, v114
    v_exp_f32 v115, v115
    v_mfma_f32_32x32x16_bf16 v[16:31], v[76:79], v[132:135], v[16:31]
    ds_read_b64_tr_b16 v[72:73], v178 offset:1536
    ds_read_b64_tr_b16 v[74:75], v178 offset:1920
    ds_read_b64_tr_b16 v[76:77], v178 offset:2304
    ds_read_b64_tr_b16 v[78:79], v178 offset:2688
    s_waitcnt lgkmcnt(4)
    v_mfma_f32_32x32x16_bf16 v[128:143], v[88:91], v[96:99], v[160:175]
    v_exp_f32 v116, v116
    v_exp_f32 v117, v117
    v_exp_f32 v118, v118
    v_exp_f32 v119, v119
    v_cvt_pk_bf16_f32 v112, v112, v113
    v_cvt_pk_bf16_f32 v113, v114, v115
    v_exp_f32 v120, v120
    v_exp_f32 v121, v121
    v_exp_f32 v122, v122
    v_exp_f32 v123, v123
    v_mfma_f32_32x32x16_bf16 v[128:143], v[92:95], v[100:103], v[128:143]
    v_cvt_pk_bf16_f32 v114, v116, v117
    v_cvt_pk_bf16_f32 v115, v118, v119
    v_exp_f32 v124, v124
    v_exp_f32 v125, v125
    v_exp_f32 v126, v126
    v_exp_f32 v127, v127
    v_mfma_f32_32x32x16_bf16 v[16:31], v[64:67], v[112:115], v[16:31]
    v_cvt_pk_bf16_f32 v116, v120, v121
    v_cvt_pk_bf16_f32 v117, v122, v123
    v_cvt_pk_bf16_f32 v118, v124, v125
    v_cvt_pk_bf16_f32 v119, v126, v127
    ds_read_b128 v[80:83], v176 offset:0
    ds_read_b128 v[84:87], v177 offset:0
    v_exp_f32 v128, v128
    v_exp_f32 v129, v129
    v_exp_f32 v130, v130
    v_exp_f32 v131, v131
    v_mfma_f32_32x32x16_bf16 v[16:31], v[68:71], v[116:119], v[16:31]
    ds_read_b64_tr_b16 v[64:65], v178 offset:0
    ds_read_b64_tr_b16 v[66:67], v178 offset:384
    ds_read_b64_tr_b16 v[68:69], v178 offset:768
    ds_read_b64_tr_b16 v[70:71], v178 offset:1152
    s_waitcnt lgkmcnt(4)
    v_mfma_f32_32x32x16_bf16 v[112:127], v[80:83], v[96:99], v[48:63]
    v_exp_f32 v132, v132
    v_exp_f32 v133, v133
    v_exp_f32 v134, v134
    v_exp_f32 v135, v135
    v_cvt_pk_bf16_f32 v128, v128, v129
    v_cvt_pk_bf16_f32 v129, v130, v131
    v_exp_f32 v136, v136
    v_exp_f32 v137, v137
    v_exp_f32 v138, v138
    v_exp_f32 v139, v139
    v_mfma_f32_32x32x16_bf16 v[112:127], v[84:87], v[100:103], v[112:127]
    v_cvt_pk_bf16_f32 v130, v132, v133
    v_cvt_pk_bf16_f32 v131, v134, v135
    v_exp_f32 v140, v140
    v_exp_f32 v141, v141
    v_exp_f32 v142, v142
    v_exp_f32 v143, v143
    v_mfma_f32_32x32x16_bf16 v[16:31], v[72:75], v[128:131], v[16:31]
    v_cvt_pk_bf16_f32 v132, v136, v137
    v_cvt_pk_bf16_f32 v133, v138, v139
    v_cvt_pk_bf16_f32 v134, v140, v141
    v_cvt_pk_bf16_f32 v135, v142, v143
    s_nop 0
    v_exp_f32 v112, v112
    v_exp_f32 v113, v113
    v_exp_f32 v114, v114
    v_exp_f32 v115, v115
    v_mfma_f32_32x32x16_bf16 v[16:31], v[76:79], v[132:135], v[16:31]
    v_exp_f32 v116, v116
    v_exp_f32 v117, v117
    v_exp_f32 v118, v118
    v_exp_f32 v119, v119
    v_cvt_pk_bf16_f32 v112, v112, v113
    v_cvt_pk_bf16_f32 v113, v114, v115
    v_exp_f32 v120, v120
    v_exp_f32 v121, v121
    v_exp_f32 v122, v122
    v_exp_f32 v123, v123
    v_cvt_pk_bf16_f32 v114, v116, v117
    v_cvt_pk_bf16_f32 v115, v118, v119
    s_waitcnt lgkmcnt(0)
    v_exp_f32 v124, v124
    v_exp_f32 v125, v125
    v_exp_f32 v126, v126
    v_exp_f32 v127, v127
    v_mfma_f32_32x32x16_bf16 v[16:31], v[64:67], v[112:115], v[16:31]
    v_cvt_pk_bf16_f32 v116, v120, v121
    v_cvt_pk_bf16_f32 v117, v122, v123
    v_cvt_pk_bf16_f32 v118, v124, v125
    v_cvt_pk_bf16_f32 v119, v126, v127
    s_nop 1
    v_mfma_f32_32x32x16_bf16 v[16:31], v[68:71], v[116:119], v[16:31]
AT_DONE_86:
    s_lshl_b32 s50, s36, 4
    s_lshl_b32 s51, s43, 1
    s_add_u32 s50, s50, s51
    s_mul_i32 s50, s50, 21504
    s_add_u32 s50, s50, s47
    s_nop 6
    v_cndmask_b32 v10, v24, v28, s[44:45]
    v_rcp_f32 v10, v10
    s_nop 0
    v_mul_f32 v16, v10, v16
    v_mul_f32 v17, v10, v17
    v_mul_f32 v18, v10, v18
    v_mul_f32 v19, v10, v19
    v_mul_f32 v20, v10, v20
    v_mul_f32 v21, v10, v21
    v_mul_f32 v22, v10, v22
    v_mul_f32 v23, v10, v23
    v_mul_f32 v24, v10, v24
    v_mul_f32 v25, v10, v25
    v_mul_f32 v26, v10, v26
    v_mul_f32 v27, v10, v27
    v_cvt_pk_bf16_f32 v32, v16, v17
    v_cvt_pk_bf16_f32 v33, v18, v19
    v_cvt_pk_bf16_f32 v34, v20, v21
    v_cvt_pk_bf16_f32 v35, v22, v23
    v_cvt_pk_bf16_f32 v36, v24, v25
    v_cvt_pk_bf16_f32 v37, v26, v27
    buffer_store_dwordx2 v[32:33], v179, s[4:7], s50 offen
    buffer_store_dwordx2 v[34:35], v180, s[4:7], s50 offen
    s_mov_b64 exec, 0xffffffff
    buffer_store_dwordx2 v[36:37], v181, s[4:7], s50 offen
    s_mov_b64 exec, -1
    s_waitcnt vmcnt(0)
    s_cmp_ge_u32 s38, 4
    s_cbranch_scc1 W_154
    s_and_b32 s50, s37, 7
    s_add_u32 s50, s50, 8
    s_mul_i32 s50, s50, 102400
    s_sub_u32 s51, s38, 0
    s_mul_i32 s51, s51, 25600
    s_add_u32 s50, s50, s51
    s_add_u32 s50, s50, 76546048
    s_add_u32 s51, s51, 61440
    s_add_u32 m0, s51, 0
    s_add_u32 s52, s50, 0
    buffer_load_dwordx4 v2, s[4:7], s52 offen sc1 lds
    s_add_u32 m0, s51, 1024
    s_add_u32 s52, s50, 1024
    buffer_load_dwordx4 v2, s[4:7], s52 offen sc1 lds
    s_add_u32 m0, s51, 2048
    s_add_u32 s52, s50, 2048
    buffer_load_dwordx4 v2, s[4:7], s52 offen sc1 lds
    s_add_u32 m0, s51, 3072
    s_add_u32 s52, s50, 3072
    buffer_load_dwordx4 v2, s[4:7], s52 offen sc1 lds
    s_add_u32 m0, s51, 4096
    s_add_u32 s52, s50, 4096
    buffer_load_dwordx4 v2, s[4:7], s52 offen sc1 lds
    s_add_u32 m0, s51, 5120
    s_add_u32 s52, s50, 5120
    buffer_load_dwordx4 v2, s[4:7], s52 offen sc1 lds
    s_add_u32 m0, s51, 6144
    s_add_u32 s52, s50, 6144
    buffer_load_dwordx4 v2, s[4:7], s52 offen sc1 lds
    s_add_u32 m0, s51, 7168
    s_add_u32 s52, s50, 7168
    buffer_load_dwordx4 v2, s[4:7], s52 offen sc1 lds
    s_add_u32 m0, s51, 8192
    s_add_u32 s52, s50, 8192
    buffer_load_dwordx4 v2, s[4:7], s52 offen sc1 lds
    s_add_u32 m0, s51, 9216
    s_add_u32 s52, s50, 9216
    buffer_load_dwordx4 v2, s[4:7], s52 offen sc1 lds
    s_add_u32 m0, s51, 10240
    s_add_u32 s52, s50, 10240
    buffer_load_dwordx4 v2, s[4:7], s52 offen sc1 lds
    s_add_u32 m0, s51, 11264
    s_add_u32 s52, s50, 11264
    buffer_load_dwordx4 v2, s[4:7], s52 offen sc1 lds
    s_add_u32 m0, s51, 12288
    s_add_u32 s52, s50, 12288
    buffer_load_dwordx4 v2, s[4:7], s52 offen sc1 lds
    s_add_u32 m0, s51, 13312
    s_add_u32 s52, s50, 13312
    buffer_load_dwordx4 v2, s[4:7], s52 offen sc1 lds
    s_add_u32 m0, s51, 14336
    s_add_u32 s52, s50, 14336
    buffer_load_dwordx4 v2, s[4:7], s52 offen sc1 lds
    s_add_u32 m0, s51, 15360
    s_add_u32 s52, s50, 15360
    buffer_load_dwordx4 v2, s[4:7], s52 offen sc1 lds
    s_add_u32 m0, s51, 16384
    s_add_u32 s52, s50, 16384
    buffer_load_dwordx4 v2, s[4:7], s52 offen sc1 lds
    s_add_u32 m0, s51, 17408
    s_add_u32 s52, s50, 17408
    buffer_load_dwordx4 v2, s[4:7], s52 offen sc1 lds
    s_add_u32 m0, s51, 18432
    s_add_u32 s52, s50, 18432
    buffer_load_dwordx4 v2, s[4:7], s52 offen sc1 lds
    s_add_u32 m0, s51, 19456
    s_add_u32 s52, s50, 19456
    buffer_load_dwordx4 v2, s[4:7], s52 offen sc1 lds
    s_add_u32 m0, s51, 20480
    s_add_u32 s52, s50, 20480
    buffer_load_dwordx4 v2, s[4:7], s52 offen sc1 lds
    s_add_u32 m0, s51, 21504
    s_add_u32 s52, s50, 21504
    buffer_load_dwordx4 v2, s[4:7], s52 offen sc1 lds
    s_add_u32 m0, s51, 22528
    s_add_u32 s52, s50, 22528
    buffer_load_dwordx4 v2, s[4:7], s52 offen sc1 lds
    s_add_u32 m0, s51, 23552
    s_add_u32 s52, s50, 23552
    buffer_load_dwordx4 v2, s[4:7], s52 offen sc1 lds
    s_add_u32 m0, s51, 24576
    s_add_u32 s52, s50, 24576
    buffer_load_dwordx4 v2, s[4:7], s52 offen sc1 lds
W_154:
    s_lshr_b32 s50, s37, 3
    s_and_b32 s51, s37, 7
    s_and_b32 s52, s38, 1
    s_lshr_b32 s53, s38, 1
    s_lshl_b32 s54, s36, 4
    s_lshl_b32 s55, s50, 2
    s_add_u32 s54, s54, s55
    s_lshl_b32 s55, s52, 1
    s_add_u32 s54, s54, s55
    s_mul_i32 s55, s54, 21504
    s_mul_i32 s56, s53, 10240
    s_add_u32 s55, s55, s56
    s_add_u32 s55, s55, s47
    s_add_u32 s56, s55, 21504
    s_cmp_eq_u32 s53, 0
    s_cselect_b32 s57, s55, s56
    s_cselect_b32 s56, s56, s55
    s_mov_b32 s55, s57
    s_mov_b32 s84, s51
    s_mov_b32 s85, s53
    s_mov_b32 s86, s54
    s_mov_b32 s87, s55
    s_mov_b32 s98, s56
    s_barrier
    s_add_u32 s41, s41, 1
    s_cmp_lg_u32 s38, 4
    s_cbranch_scc1 LB_NOT0_155
    s_lshl_b32 s50, s36, 8
    s_add_u32 s50, s50, 0
    s_lshl_b32 s51, s37, 2
    s_add_u32 s51, s51, s50
    s_add_u32 s62, s41, s93
    v_mov_b32 v10, s62
    v_mov_b32 v11, 0
    s_cmp_lg_u32 s39, 0
    s_cbranch_scc1 LB_GEN_157
    s_mov_b64 exec, 1
    buffer_store_dword v10, v11, s[4:7], s51 offen
    s_mov_b64 exec, -1
    s_branch LB_ST_158
LB_GEN_157:
    buffer_wbl2 sc1
    s_waitcnt vmcnt(0)
    s_mov_b64 exec, 1
    buffer_store_dword v10, v11, s[4:7], s51 offen sc1
    s_mov_b64 exec, -1
LB_ST_158:
    v_and_b32 v11, 31, v1
    v_lshlrev_b32 v11, 2, v11
    s_cmp_lg_u32 s40, 0
    s_cbranch_scc1 PFD_160
    s_mov_b32 s60, 0
    s_add_u32 s63, s93, s41
    buffer_load_dword v182, v11, s[4:7], s50 offen sc1
    s_sleep 1
    buffer_load_dword v183, v11, s[4:7], s50 offen sc1
    s_sleep 1
    buffer_load_dword v186, v11, s[4:7], s50 offen sc1
    s_sleep 1
    buffer_load_dword v187, v11, s[4:7], s50 offen sc1
PF_159:
    s_waitcnt vmcnt(3)
    v_subrev_u32 v12, s63, v182
    v_cmp_lt_u32 vcc, 7, v12
    s_nop 3
    s_and_b32 s61, vcc_lo, 0xffffffff
    s_cmp_eq_u32 s61, 0
    s_cbranch_scc1 PFD_160
    buffer_load_dword v182, v11, s[4:7], s50 offen sc1
    s_waitcnt vmcnt(3)
    v_subrev_u32 v12, s63, v183
    v_cmp_lt_u32 vcc, 7, v12
    s_nop 3
    s_and_b32 s61, vcc_lo, 0xffffffff
    s_cmp_eq_u32 s61, 0
    s_cbranch_scc1 PFD_160
    buffer_load_dword v183, v11, s[4:7], s50 offen sc1
    s_waitcnt vmcnt(3)
    v_subrev_u32 v12, s63, v186
    v_cmp_lt_u32 vcc, 7, v12
    s_nop 3
    s_and_b32 s61, vcc_lo, 0xffffffff
    s_cmp_eq_u32 s61, 0
    s_cbranch_scc1 PFD_160
    buffer_load_dword v186, v11, s[4:7], s50 offen sc1
    s_waitcnt vmcnt(3)
    v_subrev_u32 v12, s63, v187
    v_cmp_lt_u32 vcc, 7, v12
    s_nop 3
    s_and_b32 s61, vcc_lo, 0xffffffff
    s_cmp_eq_u32 s61, 0
    s_cbranch_scc1 PFD_160
    buffer_load_dword v187, v11, s[4:7], s50 offen sc1
    s_add_u32 s60, s60, 1
    s_cmp_lt_u32 s60, 10000
    s_cbranch_scc1 PF_159
    s_mov_b32 s40, 1
PFD_160:
    s_cmp_eq_u32 s39, 0
    s_cbranch_scc1 LB_NOINV_161
    buffer_inv sc1
    s_waitcnt vmcnt(0)
LB_NOINV_161:
    s_branch LB_END_156
LB_NOT0_155:
    s_waitcnt vmcnt(0)
LB_END_156:
    s_barrier
    s_branch L_BAR1DONE
L_ODONE:
    s_lshr_b32 s50, s37, 3
    s_and_b32 s51, s37, 7
    s_and_b32 s52, s38, 1
    s_lshr_b32 s53, s38, 1
    s_lshl_b32 s54, s36, 4
    s_lshl_b32 s55, s50, 2
    s_add_u32 s54, s54, s55
    s_lshl_b32 s55, s52, 1
    s_add_u32 s54, s54, s55
    s_mul_i32 s55, s54, 21504
    s_mul_i32 s56, s53, 10240
    s_add_u32 s55, s55, s56
    s_add_u32 s55, s55, s47
    s_add_u32 s56, s55, 21504
    s_cmp_eq_u32 s53, 0
    s_cselect_b32 s57, s55, s56
    s_cselect_b32 s56, s56, s55
    s_mov_b32 s55, s57
    s_mov_b32 s84, s51
    s_mov_b32 s85, s53
    s_mov_b32 s86, s54
    s_mov_b32 s87, s55
    s_mov_b32 s98, s56
    s_barrier
    s_add_u32 s41, s41, 1
    s_cmp_lg_u32 s38, 0
    s_cbranch_scc1 LB_NOT0_162
    s_lshl_b32 s50, s36, 8
    s_add_u32 s50, s50, 0
    s_lshl_b32 s51, s37, 2
    s_add_u32 s51, s51, s50
    s_add_u32 s62, s41, s93
    v_mov_b32 v10, s62
    v_mov_b32 v11, 0
    s_cmp_lg_u32 s39, 0
    s_cbranch_scc1 LB_GEN_164
    s_mov_b64 exec, 1
    buffer_store_dword v10, v11, s[4:7], s51 offen
    s_mov_b64 exec, -1
    s_branch LB_ST_165
LB_GEN_164:
    buffer_wbl2 sc1
    s_waitcnt vmcnt(0)
    s_mov_b64 exec, 1
    buffer_store_dword v10, v11, s[4:7], s51 offen sc1
    s_mov_b64 exec, -1
LB_ST_165:
    v_and_b32 v11, 31, v1
    v_lshlrev_b32 v11, 2, v11
    s_cmp_lg_u32 s40, 0
    s_cbranch_scc1 PFD_167
    s_mov_b32 s60, 0
    s_add_u32 s63, s93, s41
    buffer_load_dword v182, v11, s[4:7], s50 offen sc1
    s_sleep 1
    buffer_load_dword v183, v11, s[4:7], s50 offen sc1
    s_sleep 1
    buffer_load_dword v186, v11, s[4:7], s50 offen sc1
    s_sleep 1
    buffer_load_dword v187, v11, s[4:7], s50 offen sc1
PF_166:
    s_waitcnt vmcnt(3)
    v_subrev_u32 v12, s63, v182
    v_cmp_lt_u32 vcc, 7, v12
    s_nop 3
    s_and_b32 s61, vcc_lo, 0xffffffff
    s_cmp_eq_u32 s61, 0
    s_cbranch_scc1 PFD_167
    buffer_load_dword v182, v11, s[4:7], s50 offen sc1
    s_waitcnt vmcnt(3)
    v_subrev_u32 v12, s63, v183
    v_cmp_lt_u32 vcc, 7, v12
    s_nop 3
    s_and_b32 s61, vcc_lo, 0xffffffff
    s_cmp_eq_u32 s61, 0
    s_cbranch_scc1 PFD_167
    buffer_load_dword v183, v11, s[4:7], s50 offen sc1
    s_waitcnt vmcnt(3)
    v_subrev_u32 v12, s63, v186
    v_cmp_lt_u32 vcc, 7, v12
    s_nop 3
    s_and_b32 s61, vcc_lo, 0xffffffff
    s_cmp_eq_u32 s61, 0
    s_cbranch_scc1 PFD_167
    buffer_load_dword v186, v11, s[4:7], s50 offen sc1
    s_waitcnt vmcnt(3)
    v_subrev_u32 v12, s63, v187
    v_cmp_lt_u32 vcc, 7, v12
    s_nop 3
    s_and_b32 s61, vcc_lo, 0xffffffff
    s_cmp_eq_u32 s61, 0
    s_cbranch_scc1 PFD_167
    buffer_load_dword v187, v11, s[4:7], s50 offen sc1
    s_add_u32 s60, s60, 1
    s_cmp_lt_u32 s60, 10000
    s_cbranch_scc1 PF_166
    s_mov_b32 s40, 1
PFD_167:
    s_cmp_eq_u32 s39, 0
    s_cbranch_scc1 LB_NOINV_168
    buffer_inv sc1
    s_waitcnt vmcnt(0)
LB_NOINV_168:
    s_branch LB_END_163
LB_NOT0_162:
    s_waitcnt vmcnt(0)
LB_END_163:
    s_barrier
L_BAR1DONE:
    s_cmp_ge_u32 s38, 4
    s_cbranch_scc1 WO_HELP_169
    s_mov_b32 s51, s84
    s_mov_b32 s53, s85
    s_mov_b32 s54, s86
    s_mov_b32 s55, s87
    s_mov_b32 s56, s98
    buffer_load_dwordx4 v[16:19], v2, s[4:7], s55 offen offset:0 sc1
    buffer_load_dwordx4 v[20:23], v2, s[4:7], s56 offen offset:0 sc1
    buffer_load_dwordx4 v[24:27], v2, s[4:7], s55 offen offset:1024 sc1
    buffer_load_dwordx4 v[28:31], v2, s[4:7], s56 offen offset:1024 sc1
    buffer_load_dwordx4 v[32:35], v2, s[4:7], s55 offen offset:2048 sc1
    buffer_load_dwordx4 v[36:39], v2, s[4:7], s56 offen offset:2048 sc1
    s_mul_i32 s60, s53, 51200
    s_add_u32 s60, s60, 61440
    v_add_u32 v11, s60, v2
    ds_read_b128 v[96:99], v11 offset:0
    ds_read_b128 v[100:103], v11 offset:1024
    ds_read_b128 v[104:107], v11 offset:2048
    ds_read_b128 v[108:111], v11 offset:3072
    ds_read_b128 v[112:115], v11 offset:4096
    s_add_u32 s57, s54, s53
    s_lshr_b32 s58, s57, 1
    s_mul_i32 s58, s58, 41984
    s_mul_i32 s59, s51, 5120
    s_add_u32 s58, s58, s59
    s_and_b32 s59, s57, 1
    s_lshl_b32 s59, s59, 8
    s_add_u32 s58, s58, s59
    s_add_u32 s59, s58, s46
    v_lshrrev_b32 v10, 5, v1
    v_lshlrev_b32 v10, 9, v10
    v_and_b32 v12, 15, v1
    v_lshlrev_b32 v12, 4, v12
    v_add_u32 v10, v10, v12
    v_bfe_u32 v12, v1, 4, 1
    v_lshlrev_b32 v12, 3, v12
    v_add_u32 v10, v10, v12
    s_waitcnt vmcnt(4)
    s_waitcnt lgkmcnt(4)
    v_mfma_f32_16x16x32_bf16 v[48:51], v[96:99], v[16:19], 0
    v_mfma_f32_16x16x32_bf16 v[68:71], v[96:99], v[20:23], 0
    ds_read_b128 v[116:119], v11 offset:5120
    s_waitcnt lgkmcnt(4)
    v_mfma_f32_16x16x32_bf16 v[52:55], v[100:103], v[16:19], 0
    v_mfma_f32_16x16x32_bf16 v[72:75], v[100:103], v[20:23], 0
    ds_read_b128 v[120:123], v11 offset:6144
    buffer_load_dwordx4 v[40:43], v2, s[4:7], s55 offen offset:3072 sc1
    buffer_load_dwordx4 v[44:47], v2, s[4:7], s56 offen offset:3072 sc1
    s_add_u32 s55, s55, 4096
    s_add_u32 s56, s56, 4096
    s_waitcnt lgkmcnt(4)
    v_mfma_f32_16x16x32_bf16 v[56:59], v[104:107], v[16:19], 0
    v_mfma_f32_16x16x32_bf16 v[76:79], v[104:107], v[20:23], 0
    ds_read_b128 v[124:127], v11 offset:7168
    s_waitcnt lgkmcnt(4)
    v_mfma_f32_16x16x32_bf16 v[60:63], v[108:111], v[16:19], 0
    v_mfma_f32_16x16x32_bf16 v[80:83], v[108:111], v[20:23], 0
    ds_read_b128 v[128:131], v11 offset:8192
    s_waitcnt lgkmcnt(4)
    v_mfma_f32_16x16x32_bf16 v[64:67], v[112:115], v[16:19], 0
    v_mfma_f32_16x16x32_bf16 v[84:87], v[112:115], v[20:23], 0
    ds_read_b128 v[132:135], v11 offset:9216
    s_waitcnt vmcnt(4)
    s_waitcnt lgkmcnt(4)
    v_mfma_f32_16x16x32_bf16 v[48:51], v[116:119], v[24:27], v[48:51]
    v_mfma_f32_16x16x32_bf16 v[68:71], v[116:119], v[28:31], v[68:71]
    ds_read_b128 v[96:99], v11 offset:10240
    s_waitcnt lgkmcnt(4)
    v_mfma_f32_16x16x32_bf16 v[52:55], v[120:123], v[24:27], v[52:55]
    v_mfma_f32_16x16x32_bf16 v[72:75], v[120:123], v[28:31], v[72:75]
    ds_read_b128 v[100:103], v11 offset:11264
    buffer_load_dwordx4 v[16:19], v2, s[4:7], s55 offen offset:0 sc1
    buffer_load_dwordx4 v[20:23], v2, s[4:7], s56 offen offset:0 sc1
    s_waitcnt lgkmcnt(4)
    v_mfma_f32_16x16x32_bf16 v[56:59], v[124:127], v[24:27], v[56:59]
    v_mfma_f32_16x16x32_bf16 v[76:79], v[124:127], v[28:31], v[76:79]
    ds_read_b128 v[104:107], v11 offset:12288
    s_waitcnt lgkmcnt(4)
    v_mfma_f32_16x16x32_bf16 v[60:63], v[128:131], v[24:27], v[60:63]
    v_mfma_f32_16x16x32_bf16 v[80:83], v[128:131], v[28:31], v[80:83]
    ds_read_b128 v[108:111], v11 offset:13312
    s_waitcnt lgkmcnt(4)
    v_mfma_f32_16x16x32_bf16 v[64:67], v[132:135], v[24:27], v[64:67]
    v_mfma_f32_16x16x32_bf16 v[84:87], v[132:135], v[28:31], v[84:87]
    ds_read_b128 v[112:115], v11 offset:14336
    s_waitcnt vmcnt(4)
    s_waitcnt lgkmcnt(4)
    v_mfma_f32_16x16x32_bf16 v[48:51], v[96:99], v[32:35], v[48:51]
    v_mfma_f32_16x16x32_bf16 v[68:71], v[96:99], v[36:39], v[68:71]
    ds_read_b128 v[116:119], v11 offset:15360
    s_waitcnt lgkmcnt(4)
    v_mfma_f32_16x16x32_bf16 v[52:55], v[100:103], v[32:35], v[52:55]
    v_mfma_f32_16x16x32_bf16 v[72:75], v[100:103], v[36:39], v[72:75]
    ds_read_b128 v[120:123], v11 offset:16384
    buffer_load_dwordx4 v[24:27], v2, s[4:7], s55 offen offset:1024 sc1
    buffer_load_dwordx4 v[28:31], v2, s[4:7], s56 offen offset:1024 sc1
    s_waitcnt lgkmcnt(4)
    v_mfma_f32_16x16x32_bf16 v[56:59], v[104:107], v[32:35], v[56:59]
    v_mfma_f32_16x16x32_bf16 v[76:79], v[104:107], v[36:39], v[76:79]
    ds_read_b128 v[124:127], v11 offset:17408
    s_waitcnt lgkmcnt(4)
    v_mfma_f32_16x16x32_bf16 v[60:63], v[108:111], v[32:35], v[60:63]
    v_mfma_f32_16x16x32_bf16 v[80:83], v[108:111], v[36:39], v[80:83]
    ds_read_b128 v[128:131], v11 offset:18432
    s_waitcnt lgkmcnt(4)
    v_mfma_f32_16x16x32_bf16 v[64:67], v[112:115], v[32:35], v[64:67]
    v_mfma_f32_16x16x32_bf16 v[84:87], v[112:115], v[36:39], v[84:87]
    ds_read_b128 v[132:135], v11 offset:19456
    s_waitcnt vmcnt(4)
    s_waitcnt lgkmcnt(4)
    v_mfma_f32_16x16x32_bf16 v[48:51], v[116:119], v[40:43], v[48:51]
    v_mfma_f32_16x16x32_bf16 v[68:71], v[116:119], v[44:47], v[68:71]
    ds_read_b128 v[96:99], v11 offset:20480
    s_waitcnt lgkmcnt(4)
    v_mfma_f32_16x16x32_bf16 v[52:55], v[120:123], v[40:43], v[52:55]
    v_mfma_f32_16x16x32_bf16 v[72:75], v[120:123], v[44:47], v[72:75]
    ds_read_b128 v[100:103], v11 offset:21504
    buffer_load_dwordx4 v[32:35], v2, s[4:7], s55 offen offset:2048 sc1
    buffer_load_dwordx4 v[36:39], v2, s[4:7], s56 offen offset:2048 sc1
    s_waitcnt lgkmcnt(4)
    v_mfma_f32_16x16x32_bf16 v[56:59], v[124:127], v[40:43], v[56:59]
    v_mfma_f32_16x16x32_bf16 v[76:79], v[124:127], v[44:47], v[76:79]
    ds_read_b128 v[104:107], v11 offset:22528
    s_waitcnt lgkmcnt(4)
    v_mfma_f32_16x16x32_bf16 v[60:63], v[128:131], v[40:43], v[60:63]
    v_mfma_f32_16x16x32_bf16 v[80:83], v[128:131], v[44:47], v[80:83]
    ds_read_b128 v[108:111], v11 offset:23552
    s_waitcnt lgkmcnt(4)
    v_mfma_f32_16x16x32_bf16 v[64:67], v[132:135], v[40:43], v[64:67]
    v_mfma_f32_16x16x32_bf16 v[84:87], v[132:135], v[44:47], v[84:87]
    ds_read_b128 v[112:115], v11 offset:24576
    s_waitcnt vmcnt(4)
    s_waitcnt lgkmcnt(4)
    v_mfma_f32_16x16x32_bf16 v[48:51], v[96:99], v[16:19], v[48:51]
    v_mfma_f32_16x16x32_bf16 v[68:71], v[96:99], v[20:23], v[68:71]
    ds_read_b128 v[116:119], v11 offset:25600
    s_waitcnt lgkmcnt(4)
    v_mfma_f32_16x16x32_bf16 v[52:55], v[100:103], v[16:19], v[52:55]
    v_mfma_f32_16x16x32_bf16 v[72:75], v[100:103], v[20:23], v[72:75]
    ds_read_b128 v[120:123], v11 offset:26624
    buffer_load_dwordx4 v[40:43], v2, s[4:7], s55 offen offset:3072 sc1
    buffer_load_dwordx4 v[44:47], v2, s[4:7], s56 offen offset:3072 sc1
    s_add_u32 s55, s55, 4096
    s_add_u32 s56, s56, 4096
    s_waitcnt lgkmcnt(4)
    v_mfma_f32_16x16x32_bf16 v[56:59], v[104:107], v[16:19], v[56:59]
    v_mfma_f32_16x16x32_bf16 v[76:79], v[104:107], v[20:23], v[76:79]
    ds_read_b128 v[124:127], v11 offset:27648
    s_waitcnt lgkmcnt(4)
    v_mfma_f32_16x16x32_bf16 v[60:63], v[108:111], v[16:19], v[60:63]
    v_mfma_f32_16x16x32_bf16 v[80:83], v[108:111], v[20:23], v[80:83]
    ds_read_b128 v[128:131], v11 offset:28672
    s_waitcnt lgkmcnt(4)
    v_mfma_f32_16x16x32_bf16 v[64:67], v[112:115], v[16:19], v[64:67]
    v_mfma_f32_16x16x32_bf16 v[84:87], v[112:115], v[20:23], v[84:87]
    ds_read_b128 v[132:135], v11 offset:29696
    s_waitcnt vmcnt(4)
    s_waitcnt lgkmcnt(4)
    v_mfma_f32_16x16x32_bf16 v[48:51], v[116:119], v[24:27], v[48:51]
    v_mfma_f32_16x16x32_bf16 v[68:71], v[116:119], v[28:31], v[68:71]
    ds_read_b128 v[96:99], v11 offset:30720
    s_waitcnt lgkmcnt(4)
    v_mfma_f32_16x16x32_bf16 v[52:55], v[120:123], v[24:27], v[52:55]
    v_mfma_f32_16x16x32_bf16 v[72:75], v[120:123], v[28:31], v[72:75]
    ds_read_b128 v[100:103], v11 offset:31744
    buffer_load_dwordx4 v[16:19], v2, s[4:7], s55 offen offset:0 sc1
    buffer_load_dwordx4 v[20:23], v2, s[4:7], s56 offen offset:0 sc1
    s_waitcnt lgkmcnt(4)
    v_mfma_f32_16x16x32_bf16 v[56:59], v[124:127], v[24:27], v[56:59]
    v_mfma_f32_16x16x32_bf16 v[76:79], v[124:127], v[28:31], v[76:79]
    ds_read_b128 v[104:107], v11 offset:32768
    s_waitcnt lgkmcnt(4)
    v_mfma_f32_16x16x32_bf16 v[60:63], v[128:131], v[24:27], v[60:63]
    v_mfma_f32_16x16x32_bf16 v[80:83], v[128:131], v[28:31], v[80:83]
    ds_read_b128 v[108:111], v11 offset:33792
    buffer_load_dwordx2 v[88:89], v10, s[4:7], s59 offen offset:0 sc1
    s_waitcnt lgkmcnt(4)
    v_mfma_f32_16x16x32_bf16 v[64:67], v[132:135], v[24:27], v[64:67]
    v_mfma_f32_16x16x32_bf16 v[84:87], v[132:135], v[28:31], v[84:87]
    ds_read_b128 v[112:115], v11 offset:34816
    s_waitcnt vmcnt(5)
    s_waitcnt lgkmcnt(4)
    v_mfma_f32_16x16x32_bf16 v[48:51], v[96:99], v[32:35], v[48:51]
    v_mfma_f32_16x16x32_bf16 v[68:71], v[96:99], v[36:39], v[68:71]
    ds_read_b128 v[116:119], v11 offset:35840
    s_waitcnt lgkmcnt(4)
    v_mfma_f32_16x16x32_bf16 v[52:55], v[100:103], v[32:35], v[52:55]
    v_mfma_f32_16x16x32_bf16 v[72:75], v[100:103], v[36:39], v[72:75]
    ds_read_b128 v[120:123], v11 offset:36864
    buffer_load_dwordx4 v[24:27], v2, s[4:7], s55 offen offset:1024 sc1
    buffer_load_dwordx4 v[28:31], v2, s[4:7], s56 offen offset:1024 sc1
    s_waitcnt lgkmcnt(4)
    v_mfma_f32_16x16x32_bf16 v[56:59], v[104:107], v[32:35], v[56:59]
    v_mfma_f32_16x16x32_bf16 v[76:79], v[104:107], v[36:39], v[76:79]
    ds_read_b128 v[124:127], v11 offset:37888
    s_waitcnt lgkmcnt(4)
    v_mfma_f32_16x16x32_bf16 v[60:63], v[108:111], v[32:35], v[60:63]
    v_mfma_f32_16x16x32_bf16 v[80:83], v[108:111], v[36:39], v[80:83]
    ds_read_b128 v[128:131], v11 offset:38912
    buffer_load_dwordx2 v[90:91], v10, s[4:7], s59 offen offset:1024 sc1
    s_waitcnt lgkmcnt(4)
    v_mfma_f32_16x16x32_bf16 v[64:67], v[112:115], v[32:35], v[64:67]
    v_mfma_f32_16x16x32_bf16 v[84:87], v[112:115], v[36:39], v[84:87]
    ds_read_b128 v[132:135], v11 offset:39936
    s_waitcnt vmcnt(6)
    s_waitcnt lgkmcnt(4)
    v_mfma_f32_16x16x32_bf16 v[48:51], v[116:119], v[40:43], v[48:51]
    v_mfma_f32_16x16x32_bf16 v[68:71], v[116:119], v[44:47], v[68:71]
    ds_read_b128 v[96:99], v11 offset:40960
    s_waitcnt lgkmcnt(4)
    v_mfma_f32_16x16x32_bf16 v[52:55], v[120:123], v[40:43], v[52:55]
    v_mfma_f32_16x16x32_bf16 v[72:75], v[120:123], v[44:47], v[72:75]
    ds_read_b128 v[100:103], v11 offset:41984
    s_waitcnt lgkmcnt(4)
    v_mfma_f32_16x16x32_bf16 v[56:59], v[124:127], v[40:43], v[56:59]
    v_mfma_f32_16x16x32_bf16 v[76:79], v[124:127], v[44:47], v[76:79]
    ds_read_b128 v[104:107], v11 offset:43008
    s_waitcnt lgkmcnt(4)
    v_mfma_f32_16x16x32_bf16 v[60:63], v[128:131], v[40:43], v[60:63]
    v_mfma_f32_16x16x32_bf16 v[80:83], v[128:131], v[44:47], v[80:83]
    ds_read_b128 v[108:111], v11 offset:44032
    buffer_load_dwordx2 v[92:93], v10, s[4:7], s59 offen offset:2048 sc1
    s_waitcnt lgkmcnt(4)
    v_mfma_f32_16x16x32_bf16 v[64:67], v[132:135], v[40:43], v[64:67]
    v_mfma_f32_16x16x32_bf16 v[84:87], v[132:135], v[44:47], v[84:87]
    ds_read_b128 v[112:115], v11 offset:45056
    s_waitcnt vmcnt(5)
    s_waitcnt lgkmcnt(4)
    v_mfma_f32_16x16x32_bf16 v[48:51], v[96:99], v[16:19], v[48:51]
    v_mfma_f32_16x16x32_bf16 v[68:71], v[96:99], v[20:23], v[68:71]
    ds_read_b128 v[116:119], v11 offset:46080
    s_waitcnt lgkmcnt(4)
    v_mfma_f32_16x16x32_bf16 v[52:55], v[100:103], v[16:19], v[52:55]
    v_mfma_f32_16x16x32_bf16 v[72:75], v[100:103], v[20:23], v[72:75]
    ds_read_b128 v[120:123], v11 offset:47104
    s_waitcnt lgkmcnt(4)
    v_mfma_f32_16x16x32_bf16 v[56:59], v[104:107], v[16:19], v[56:59]
    v_mfma_f32_16x16x32_bf16 v[76:79], v[104:107], v[20:23], v[76:79]
    ds_read_b128 v[124:127], v11 offset:48128
    s_waitcnt lgkmcnt(4)
    v_mfma_f32_16x16x32_bf16 v[60:63], v[108:111], v[16:19], v[60:63]
    v_mfma_f32_16x16x32_bf16 v[80:83], v[108:111], v[20:23], v[80:83]
    ds_read_b128 v[128:131], v11 offset:49152
    buffer_load_dwordx2 v[94:95], v10, s[4:7], s59 offen offset:3072 sc1
    s_waitcnt lgkmcnt(4)
    v_mfma_f32_16x16x32_bf16 v[64:67], v[112:115], v[16:19], v[64:67]
    v_mfma_f32_16x16x32_bf16 v[84:87], v[112:115], v[20:23], v[84:87]
    ds_read_b128 v[132:135], v11 offset:50176
    s_waitcnt vmcnt(3)
    s_waitcnt lgkmcnt(4)
    v_mfma_f32_16x16x32_bf16 v[48:51], v[116:119], v[24:27], v[48:51]
    v_mfma_f32_16x16x32_bf16 v[68:71], v[116:119], v[28:31], v[68:71]
    s_waitcnt lgkmcnt(3)
    v_mfma_f32_16x16x32_bf16 v[52:55], v[120:123], v[24:27], v[52:55]
    v_mfma_f32_16x16x32_bf16 v[72:75], v[120:123], v[28:31], v[72:75]
    s_waitcnt lgkmcnt(2)
    v_mfma_f32_16x16x32_bf16 v[56:59], v[124:127], v[24:27], v[56:59]
    v_mfma_f32_16x16x32_bf16 v[76:79], v[124:127], v[28:31], v[76:79]
    s_waitcnt lgkmcnt(1)
    v_mfma_f32_16x16x32_bf16 v[60:63], v[128:131], v[24:27], v[60:63]
    v_mfma_f32_16x16x32_bf16 v[80:83], v[128:131], v[28:31], v[80:83]
    s_add_u32 s59, s59, 4096
    buffer_load_dwordx2 v[136:137], v10, s[4:7], s59 offen offset:0 sc1
    s_waitcnt lgkmcnt(0)
    v_mfma_f32_16x16x32_bf16 v[64:67], v[132:135], v[24:27], v[64:67]
    v_mfma_f32_16x16x32_bf16 v[84:87], v[132:135], v[28:31], v[84:87]
    s_mul_i32 s60, s38, 5120
    s_add_u32 s60, s60, 0
    v_add_u32 v12, s60, v2
    ds_write_b128 v12, v[68:71] offset:0
    ds_write_b128 v12, v[72:75] offset:1024
    ds_write_b128 v12, v[76:79] offset:2048
    ds_write_b128 v12, v[80:83] offset:3072
    s_nop 0
    ds_write_b128 v12, v[84:87] offset:4096
    s_waitcnt vmcnt(0)
    v_lshlrev_b32 v100, 16, v88
    v_and_b32 v101, 0xffff0000, v88
    v_lshlrev_b32 v102, 16, v89
    v_and_b32 v103, 0xffff0000, v89
    v_add_f32 v48, v48, v100
    v_add_f32 v49, v49, v101
    v_add_f32 v50, v50, v102
    v_add_f32 v51, v51, v103
    v_lshlrev_b32 v104, 16, v90
    v_and_b32 v105, 0xffff0000, v90
    v_lshlrev_b32 v106, 16, v91
    v_and_b32 v107, 0xffff0000, v91
    v_add_f32 v52, v52, v104
    v_add_f32 v53, v53, v105
    v_add_f32 v54, v54, v106
    v_add_f32 v55, v55, v107
    v_lshlrev_b32 v108, 16, v92
    v_and_b32 v109, 0xffff0000, v92
    v_lshlrev_b32 v110, 16, v93
    v_and_b32 v111, 0xffff0000, v93
    v_add_f32 v56, v56, v108
    v_add_f32 v57, v57, v109
    v_add_f32 v58, v58, v110
    v_add_f32 v59, v59, v111
    v_lshlrev_b32 v112, 16, v94
    v_and_b32 v113, 0xffff0000, v94
    v_lshlrev_b32 v114, 16, v95
    v_and_b32 v115, 0xffff0000, v95
    v_add_f32 v60, v60, v112
    v_add_f32 v61, v61, v113
    v_add_f32 v62, v62, v114
    v_add_f32 v63, v63, v115
    v_lshlrev_b32 v116, 16, v136
    v_and_b32 v117, 0xffff0000, v136
    v_lshlrev_b32 v118, 16, v137
    v_and_b32 v119, 0xffff0000, v137
    v_add_f32 v64, v64, v116
    v_add_f32 v65, v65, v117
    v_add_f32 v66, v66, v118
    v_add_f32 v67, v67, v119
    s_waitcnt lgkmcnt(0)
WO_HELP_169:
    s_barrier
    s_cmp_ge_u32 s38, 4
    s_cbranch_scc1 WO_H2_170
    s_xor_b32 s60, s38, 2
    s_mul_i32 s60, s60, 5120
    s_add_u32 s60, s60, 0
    v_add_u32 v12, s60, v2
    ds_read_b128 v[16:19], v12 offset:0
    ds_read_b128 v[20:23], v12 offset:1024
    ds_read_b128 v[24:27], v12 offset:2048
    ds_read_b128 v[28:31], v12 offset:3072
    ds_read_b128 v[32:35], v12 offset:4096
    s_waitcnt lgkmcnt(0)
    v_pk_add_f32 v[48:49], v[48:49], v[16:17]
    v_pk_add_f32 v[50:51], v[50:51], v[18:19]
    v_cvt_pk_bf16_f32 v120, v48, v49
    v_cvt_pk_bf16_f32 v121, v50, v51
    v_pk_add_f32 v[52:53], v[52:53], v[20:21]
    v_pk_add_f32 v[54:55], v[54:55], v[22:23]
    v_cvt_pk_bf16_f32 v122, v52, v53
    v_cvt_pk_bf16_f32 v123, v54, v55
    v_pk_add_f32 v[56:57], v[56:57], v[24:25]
    v_pk_add_f32 v[58:59], v[58:59], v[26:27]
    v_cvt_pk_bf16_f32 v124, v56, v57
    v_cvt_pk_bf16_f32 v125, v58, v59
    v_pk_add_f32 v[60:61], v[60:61], v[28:29]
    v_pk_add_f32 v[62:63], v[62:63], v[30:31]
    v_cvt_pk_bf16_f32 v126, v60, v61
    v_cvt_pk_bf16_f32 v127, v62, v63
    v_pk_add_f32 v[64:65], v[64:65], v[32:33]
    v_pk_add_f32 v[66:67], v[66:67], v[34:35]
    v_cvt_pk_bf16_f32 v128, v64, v65
    v_cvt_pk_bf16_f32 v129, v66, v67
    s_cmp_eq_u32 s42, 3
    s_cbranch_scc1 WO_LAST_172
    s_add_u32 s59, s58, s90
    buffer_store_dwordx2 v[120:121], v10, s[4:7], s59 offen offset:0
    buffer_store_dwordx2 v[122:123], v10, s[4:7], s59 offen offset:1024
    buffer_store_dwordx2 v[124:125], v10, s[4:7], s59 offen offset:2048
    buffer_store_dwordx2 v[126:127], v10, s[4:7], s59 offen offset:3072
    s_add_u32 s59, s59, 4096
    buffer_store_dwordx2 v[128:129], v10, s[4:7], s59 offen offset:0
    v_pk_add_f32 v[36:37], v[48:49], v[50:51]
    v_pk_mul_f32 v[38:39], v[48:49], v[48:49]
    v_pk_fma_f32 v[38:39], v[50:51], v[50:51], v[38:39]
    v_pk_add_f32 v[36:37], v[36:37], v[52:53]
    v_pk_fma_f32 v[38:39], v[52:53], v[52:53], v[38:39]
    v_pk_add_f32 v[36:37], v[36:37], v[54:55]
    v_pk_fma_f32 v[38:39], v[54:55], v[54:55], v[38:39]
    v_pk_add_f32 v[36:37], v[36:37], v[56:57]
    v_pk_fma_f32 v[38:39], v[56:57], v[56:57], v[38:39]
    v_pk_add_f32 v[36:37], v[36:37], v[58:59]
    v_pk_fma_f32 v[38:39], v[58:59], v[58:59], v[38:39]
    v_pk_add_f32 v[36:37], v[36:37], v[60:61]
    v_pk_fma_f32 v[38:39], v[60:61], v[60:61], v[38:39]
    v_pk_add_f32 v[36:37], v[36:37], v[62:63]
    v_pk_fma_f32 v[38:39], v[62:63], v[62:63], v[38:39]
    v_pk_add_f32 v[36:37], v[36:37], v[64:65]
    v_pk_fma_f32 v[38:39], v[64:65], v[64:65], v[38:39]
    v_pk_add_f32 v[36:37], v[36:37], v[66:67]
    v_pk_fma_f32 v[38:39], v[66:67], v[66:67], v[38:39]
    v_add_f32 v40, v36, v37
    v_add_f32 v41, v38, v39
    v_mov_b32 v42, v40
    v_mov_b32 v43, v41
    s_nop 0
    v_permlane16_swap_b32 v40, v42
    v_permlane16_swap_b32 v41, v43
    v_add_f32 v40, v40, v42
    v_add_f32 v41, v41, v43
    v_mov_b32 v42, v40
    v_mov_b32 v43, v41
    s_nop 0
    v_permlane32_swap_b32 v40, v42
    v_permlane32_swap_b32 v41, v43
    v_add_f32 v40, v40, v42
    v_add_f32 v41, v41, v43
    s_lshr_b32 s60, s57, 1
    s_lshl_b32 s60, s60, 11
    s_and_b32 s61, s57, 1
    s_lshl_b32 s61, s61, 8
    s_add_u32 s60, s60, s61
    s_bfe_u32 s61, s51, 0x10001
    s_lshl_b32 s61, s61, 10
    s_add_u32 s60, s60, s61
    s_lshr_b32 s61, s51, 2
    s_lshl_b32 s61, s61, 9
    s_add_u32 s60, s60, s61
    s_and_b32 s61, s51, 1
    s_lshl_b32 s61, s61, 3
    s_add_u32 s60, s60, s61
    s_add_u32 s60, s60, s91
    v_lshlrev_b32 v42, 4, v1
    s_mov_b64 exec, 0xffff
    buffer_store_dwordx2 v[40:41], v42, s[4:7], s60 offen
    s_mov_b64 exec, -1
    s_branch WO_H3_171
WO_LAST_172:
    s_mul_i32 s60, s57, 20480
    s_mul_i32 s61, s51, 160
    s_add_u32 s60, s60, s61
    v_and_b32 v42, 15, v1
    v_mul_u32_u24 v42, 1280, v42
    v_lshrrev_b32 v43, 4, v1
    v_lshlrev_b32 v43, 3, v43
    v_add_u32 v42, v42, v43
    buffer_store_dwordx2 v[120:121], v42, s[28:31], s60 offen offset:0
    buffer_store_dwordx2 v[122:123], v42, s[28:31], s60 offen offset:32
    buffer_store_dwordx2 v[124:125], v42, s[28:31], s60 offen offset:64
    buffer_store_dwordx2 v[126:127], v42, s[28:31], s60 offen offset:96
    buffer_store_dwordx2 v[128:129], v42, s[28:31], s60 offen offset:128
    s_branch WO_H3_171
WO_H2_170:
    s_cmp_eq_u32 s42, 3
    s_cbranch_scc1 SW_E_173
    s_mul_i32 s62, s97, 10240
    s_add_u32 s62, s62, 81920
    v_add_u32 v13, s62, v2
    s_bitcmp1_b32 s42, 0
    s_cbranch_scc1 SW_A_174
    ds_write_b128 v13, v[144:147] offset:0
    ds_write_b128 v13, v[148:151] offset:1024
    ds_write_b128 v13, v[152:155] offset:2048
    ds_write_b128 v13, v[156:159] offset:3072
    ds_write_b128 v13, v[232:235] offset:4096
    ds_write_b128 v13, v[236:239] offset:5120
    ds_write_b128 v13, v[240:243] offset:6144
    ds_write_b128 v13, v[244:247] offset:7168
    ds_write_b128 v13, v[248:251] offset:8192
    ds_write_b128 v13, v[252:255] offset:9216
    s_branch SW_E_173
SW_A_174:
    ds_write_b128 v13, v[192:195] offset:0
    ds_write_b128 v13, v[196:199] offset:1024
    ds_write_b128 v13, v[200:203] offset:2048
    ds_write_b128 v13, v[204:207] offset:3072
    ds_write_b128 v13, v[208:211] offset:4096
    ds_write_b128 v13, v[212:215] offset:5120
    ds_write_b128 v13, v[216:219] offset:6144
    ds_write_b128 v13, v[220:223] offset:7168
    ds_write_b128 v13, v[224:227] offset:8192
    ds_write_b128 v13, v[228:231] offset:9216
SW_E_173:
    s_waitcnt lgkmcnt(0)
WO_H3_171:
    s_cmp_eq_u32 s42, 3
    s_cbranch_scc1 L_FIN
    s_cmp_ge_u32 s38, 4
    s_cbranch_scc1 W_175
    s_waitcnt vmcnt(0)
W_175:
    s_add_u32 s42, s42, 1
    s_mov_b32 s46, 1048576
    s_mov_b32 s90, 1048576
    s_mov_b32 s47, 16777216
    s_mov_b32 s48, 33554432
    s_mov_b32 s91, 33554432
    s_lshl_b32 s50, s36, 3
    s_add_u32 s50, s50, s43
    s_lshl_b32 s85, s50, 11
    s_add_u32 s85, s85, s48
    s_mul_i32 s84, s50, 41984
    s_add_u32 s84, s84, s46
    s_barrier
    s_add_u32 s41, s41, 1
    s_cmp_lg_u32 s38, 4
    s_cbranch_scc1 LB_NOT0_176
    s_lshl_b32 s50, s36, 8
    s_add_u32 s50, s50, 0
    s_lshl_b32 s51, s37, 2
    s_add_u32 s51, s51, s50
    s_add_u32 s62, s41, s93
    v_mov_b32 v10, s62
    v_mov_b32 v11, 0
    s_cmp_lg_u32 s39, 0
    s_cbranch_scc1 LB_GEN_178
    s_mov_b64 exec, 1
    buffer_store_dword v10, v11, s[4:7], s51 offen
    s_mov_b64 exec, -1
    s_branch LB_ST_179
LB_GEN_178:
    buffer_wbl2 sc1
    s_waitcnt vmcnt(0)
    s_mov_b64 exec, 1
    buffer_store_dword v10, v11, s[4:7], s51 offen sc1
    s_mov_b64 exec, -1
LB_ST_179:
    v_and_b32 v11, 31, v1
    v_lshlrev_b32 v11, 2, v11
    s_cmp_lg_u32 s40, 0
    s_cbranch_scc1 PFD_181
    s_mov_b32 s60, 0
    s_add_u32 s63, s93, s41
    buffer_load_dword v182, v11, s[4:7], s50 offen sc1
    s_sleep 1
    buffer_load_dword v183, v11, s[4:7], s50 offen sc1
    s_sleep 1
    buffer_load_dword v186, v11, s[4:7], s50 offen sc1
    s_sleep 1
    buffer_load_dword v187, v11, s[4:7], s50 offen sc1
PF_180:
    s_waitcnt vmcnt(3)
    v_subrev_u32 v12, s63, v182
    v_cmp_lt_u32 vcc, 7, v12
    s_nop 3
    s_and_b32 s61, vcc_lo, 0xffffffff
    s_cmp_eq_u32 s61, 0
    s_cbranch_scc1 PFD_181
    buffer_load_dword v182, v11, s[4:7], s50 offen sc1
    s_waitcnt vmcnt(3)
    v_subrev_u32 v12, s63, v183
    v_cmp_lt_u32 vcc, 7, v12
    s_nop 3
    s_and_b32 s61, vcc_lo, 0xffffffff
    s_cmp_eq_u32 s61, 0
    s_cbranch_scc1 PFD_181
    buffer_load_dword v183, v11, s[4:7], s50 offen sc1
    s_waitcnt vmcnt(3)
    v_subrev_u32 v12, s63, v186
    v_cmp_lt_u32 vcc, 7, v12
    s_nop 3
    s_and_b32 s61, vcc_lo, 0xffffffff
    s_cmp_eq_u32 s61, 0
    s_cbranch_scc1 PFD_181
    buffer_load_dword v186, v11, s[4:7], s50 offen sc1
    s_waitcnt vmcnt(3)
    v_subrev_u32 v12, s63, v187
    v_cmp_lt_u32 vcc, 7, v12
    s_nop 3
    s_and_b32 s61, vcc_lo, 0xffffffff
    s_cmp_eq_u32 s61, 0
    s_cbranch_scc1 PFD_181
    buffer_load_dword v187, v11, s[4:7], s50 offen sc1
    s_add_u32 s60, s60, 1
    s_cmp_lt_u32 s60, 10000
    s_cbranch_scc1 PF_180
    s_mov_b32 s40, 1
PFD_181:
    s_cmp_eq_u32 s39, 0
    s_cbranch_scc1 LB_NOINV_182
    buffer_inv sc1
    s_waitcnt vmcnt(0)
LB_NOINV_182:
    s_branch LB_END_177
LB_NOT0_176:
    s_cmp_ge_u32 s38, 4
    s_cbranch_scc1 W_183
    s_mul_i32 s62, s97, 10240
    s_add_u32 s62, s62, 81920
    v_add_u32 v13, s62, v2
    s_bitcmp1_b32 s42, 0
    s_cbranch_scc1 SWN_B_185
    ds_write_b128 v13, v[192:195] offset:0
    ds_write_b128 v13, v[196:199] offset:1024
    ds_write_b128 v13, v[200:203] offset:2048
    ds_write_b128 v13, v[204:207] offset:3072
    ds_write_b128 v13, v[208:211] offset:4096
    ds_write_b128 v13, v[212:215] offset:5120
    ds_write_b128 v13, v[216:219] offset:6144
    ds_write_b128 v13, v[220:223] offset:7168
    ds_write_b128 v13, v[224:227] offset:8192
    ds_write_b128 v13, v[228:231] offset:9216
    s_branch SWN_E_184
SWN_B_185:
    ds_write_b128 v13, v[144:147] offset:0
    ds_write_b128 v13, v[148:151] offset:1024
    ds_write_b128 v13, v[152:155] offset:2048
    ds_write_b128 v13, v[156:159] offset:3072
    ds_write_b128 v13, v[232:235] offset:4096
    ds_write_b128 v13, v[236:239] offset:5120
    ds_write_b128 v13, v[240:243] offset:6144
    ds_write_b128 v13, v[244:247] offset:7168
    ds_write_b128 v13, v[248:251] offset:8192
    ds_write_b128 v13, v[252:255] offset:9216
SWN_E_184:
    s_waitcnt lgkmcnt(0)
W_183:
LB_END_177:
    s_barrier
    s_branch L_LAYER
L_FIN:
    s_waitcnt vmcnt(0)
L_END:
    s_endpgm
SUB_IMPORT1:
    s_nop 4
    s_mov_b32 s96, 0
    s_cmp_eq_u32 s36, 0
    s_cbranch_scc1 S1_E_186
    s_sub_u32 s54, s2, 1
    s_lshl_b32 s52, s54, 6
    s_add_u32 s52, s52, 16384
    v_and_b32 v11, 3, v1
    v_lshlrev_b32 v11, 2, v11
    v_add_u32 v11, 48, v11
    s_add_u32 s53, s42, 1
    s_cmp_lg_u32 s40, 0
    s_cbranch_scc1 POLLD_189
    s_mov_b32 s60, 0
    s_add_u32 s63, s93, s53
POLL_188:
    buffer_load_dword v12, v11, s[4:7], s52 offen sc1
    s_waitcnt vmcnt(0)
    v_subrev_u32 v12, s63, v12
    v_cmp_lt_u32 vcc, 7, v12
    s_nop 3
    s_and_b32 s61, vcc_lo, 0xf
    s_cmp_eq_u32 s61, 0
    s_cbranch_scc1 POLLD_189
    s_add_u32 s60, s60, 1
    s_cmp_lt_u32 s60, 20000
    s_cbranch_scc1 POLL_188
    s_mov_b32 s40, 1
POLLD_189:
    s_lshr_b32 s51, s42, 1
    s_mul_i32 s51, s51, 6291456
    s_add_u32 s51, s51, 35651584
    s_mul_i32 s63, s54, 24576
    s_add_u32 s51, s51, s63
    s_add_u32 s55, s51, 18432
    s_add_u32 s51, s51, 6144
    s_lshl_b32 s52, s54, 6
    s_add_u32 s52, s52, 32784
    v_and_b32 v11, 3, v1
    v_lshlrev_b32 v11, 2, v11
    buffer_load_dword v14, v11, s[4:7], s52 offen sc1
    buffer_load_dwordx4 v[160:163], v2, s[4:7], s51 offen offset:0 sc1
    buffer_load_dwordx4 v[164:167], v2, s[4:7], s51 offen offset:1024 sc1
    buffer_load_dwordx4 v[168:171], v2, s[4:7], s51 offen offset:2048 sc1
    buffer_load_dwordx4 v[172:175], v2, s[4:7], s51 offen offset:3072 sc1
    s_add_u32 s51, s51, 4096
    buffer_load_dwordx4 v[184:187], v2, s[4:7], s51 offen offset:0 sc1
    buffer_load_dwordx4 v[108:111], v2, s[4:7], s51 offen offset:1024 sc1
    buffer_load_dwordx4 v[128:131], v2, s[4:7], s55 offen offset:0 sc1
    buffer_load_dwordx4 v[132:135], v2, s[4:7], s55 offen offset:1024 sc1
    buffer_load_dwordx4 v[136:139], v2, s[4:7], s55 offen offset:2048 sc1
    buffer_load_dwordx4 v[140:143], v2, s[4:7], s55 offen offset:3072 sc1
    s_add_u32 s55, s55, 4096
    buffer_load_dwordx4 v[48:51], v2, s[4:7], s55 offen offset:0 sc1
    buffer_load_dwordx4 v[52:55], v2, s[4:7], s55 offen offset:1024 sc1
S1_E_186:
SUB_S1FIN:
    s_nop 4
    s_cmp_eq_u32 s36, 0
    s_cbranch_scc1 S1_FILL_190
    s_waitcnt vmcnt(12)
    v_mov_b32_dpp v15, v14 row_ror:2 row_mask:0xf bank_mask:0xf
    v_max_f32 v14, v14, v15
    s_nop 1
    v_mov_b32_dpp v15, v14 row_ror:1 row_mask:0xf bank_mask:0xf
    v_max_f32 v14, v14, v15
    v_mov_b32 v12, 51232
    s_mov_b64 exec, 1
    ds_write_b32 v12, v14
    s_mov_b64 exec, -1
    s_waitcnt vmcnt(11)
    ds_write_b128 v2, v[160:163] offset:6144
    s_waitcnt vmcnt(10)
    ds_write_b128 v2, v[164:167] offset:7168
    s_waitcnt vmcnt(9)
    ds_write_b128 v2, v[168:171] offset:8192
    s_waitcnt vmcnt(8)
    ds_write_b128 v2, v[172:175] offset:9216
    s_waitcnt vmcnt(7)
    ds_write_b128 v2, v[184:187] offset:10240
    s_waitcnt vmcnt(6)
    ds_write_b128 v2, v[108:111] offset:11264
    s_waitcnt vmcnt(5)
    ds_write_b128 v2, v[128:131] offset:30720
    s_waitcnt vmcnt(4)
    ds_write_b128 v2, v[132:135] offset:31744
    s_waitcnt vmcnt(3)
    ds_write_b128 v2, v[136:139] offset:32768
    s_waitcnt vmcnt(2)
    ds_write_b128 v2, v[140:143] offset:33792
    s_waitcnt vmcnt(1)
    ds_write_b128 v2, v[48:51] offset:34816
    s_waitcnt vmcnt(0)
    ds_write_b128 v2, v[52:55] offset:35840
    s_branch S1_END_191
S1_FILL_190:
    v_mov_b32 v160, 0
    v_mov_b32 v161, 0
    v_mov_b32 v162, 0
    v_mov_b32 v163, 0
    v_mov_b32 v164, 0
    v_mov_b32 v165, 0
    v_mov_b32 v166, 0
    v_mov_b32 v167, 0
    v_add_u32 v11, 0, v1
    v_mul_u32_u24 v12, 21846, v11
    v_lshrrev_b32 v12, 16, v12
    v_mul_u32_u24 v12, 3, v12
    v_sub_u32 v12, v11, v12
    v_cmp_eq_u32 vcc, 2, v12
    v_mov_b32 v13, 0xf14a
    s_nop 0
    v_cndmask_b32 v162, v160, v13, vcc
    ds_write_b128 v2, v[160:163] offset:6144
    ds_write_b128 v2, v[164:167] offset:30720
    v_add_u32 v11, 64, v1
    v_mul_u32_u24 v12, 21846, v11
    v_lshrrev_b32 v12, 16, v12
    v_mul_u32_u24 v12, 3, v12
    v_sub_u32 v12, v11, v12
    v_cmp_eq_u32 vcc, 2, v12
    v_mov_b32 v13, 0xf14a
    s_nop 0
    v_cndmask_b32 v162, v160, v13, vcc
    ds_write_b128 v2, v[160:163] offset:7168
    ds_write_b128 v2, v[164:167] offset:31744
    v_add_u32 v11, 128, v1
    v_mul_u32_u24 v12, 21846, v11
    v_lshrrev_b32 v12, 16, v12
    v_mul_u32_u24 v12, 3, v12
    v_sub_u32 v12, v11, v12
    v_cmp_eq_u32 vcc, 2, v12
    v_mov_b32 v13, 0xf14a
    s_nop 0
    v_cndmask_b32 v162, v160, v13, vcc
    ds_write_b128 v2, v[160:163] offset:8192
    ds_write_b128 v2, v[164:167] offset:32768
    v_add_u32 v11, 192, v1
    v_mul_u32_u24 v12, 21846, v11
    v_lshrrev_b32 v12, 16, v12
    v_mul_u32_u24 v12, 3, v12
    v_sub_u32 v12, v11, v12
    v_cmp_eq_u32 vcc, 2, v12
    v_mov_b32 v13, 0xf14a
    s_nop 0
    v_cndmask_b32 v162, v160, v13, vcc
    ds_write_b128 v2, v[160:163] offset:9216
    ds_write_b128 v2, v[164:167] offset:33792
    v_add_u32 v11, 256, v1
    v_mul_u32_u24 v12, 21846, v11
    v_lshrrev_b32 v12, 16, v12
    v_mul_u32_u24 v12, 3, v12
    v_sub_u32 v12, v11, v12
    v_cmp_eq_u32 vcc, 2, v12
    v_mov_b32 v13, 0xf14a
    s_nop 0
    v_cndmask_b32 v162, v160, v13, vcc
    ds_write_b128 v2, v[160:163] offset:10240
    ds_write_b128 v2, v[164:167] offset:34816
    v_add_u32 v11, 320, v1
    v_mul_u32_u24 v12, 21846, v11
    v_lshrrev_b32 v12, 16, v12
    v_mul_u32_u24 v12, 3, v12
    v_sub_u32 v12, v11, v12
    v_cmp_eq_u32 vcc, 2, v12
    v_mov_b32 v13, 0xf14a
    s_nop 0
    v_cndmask_b32 v162, v160, v13, vcc
    ds_write_b128 v2, v[160:163] offset:11264
    ds_write_b128 v2, v[164:167] offset:35840
S1_END_191:
    s_waitcnt lgkmcnt(0)
    v_mov_b32 v11, 52232
    v_mov_b32 v12, 1
    s_mov_b64 exec, 1
    ds_add_u32 v11, v12
    s_mov_b64 exec, -1
    s_waitcnt lgkmcnt(0)
    s_nop 4
    s_setpc_b64 s[88:89]
SUB_IMPORT2:
    s_nop 4
    s_sub_u32 s55, s38, 6
    s_mul_i32 s55, s55, 24576
    v_add_u32 v13, s55, v2
    s_cmp_eq_u32 s36, 0
    s_cbranch_scc1 I2F_FILL_192
    s_cmp_eq_u32 s96, 0
    s_cbranch_scc1 I2F_GO_194
    s_sub_u32 s54, s2, 1
    s_lshl_b32 s52, s54, 6
    s_add_u32 s52, s52, 16384
    s_add_u32 s53, s42, 1
    v_and_b32 v11, 3, v1
    v_lshlrev_b32 v11, 2, v11
    v_add_u32 v11, 32, v11
    s_cmp_lg_u32 s40, 0
    s_cbranch_scc1 POLLD_196
    s_mov_b32 s60, 0
    s_add_u32 s63, s93, s53
POLL_195:
    buffer_load_dword v12, v11, s[4:7], s52 offen sc1
    s_waitcnt vmcnt(0)
    v_subrev_u32 v12, s63, v12
    v_cmp_lt_u32 vcc, 7, v12
    s_nop 3
    s_and_b32 s61, vcc_lo, 0xf
    s_cmp_eq_u32 s61, 0
    s_cbranch_scc1 POLLD_196
    s_add_u32 s60, s60, 1
    s_cmp_lt_u32 s60, 20000
    s_cbranch_scc1 POLL_195
    s_mov_b32 s40, 1
POLLD_196:
    s_sub_u32 s54, s2, 1
    s_lshr_b32 s51, s42, 1
    s_mul_i32 s51, s51, 6291456
    s_add_u32 s51, s51, 35651584
    s_mul_i32 s63, s54, 24576
    s_add_u32 s51, s51, s63
    s_sub_u32 s55, s38, 6
    s_mul_i32 s55, s55, 12288
    s_add_u32 s51, s51, s55
    s_lshl_b32 s52, s54, 6
    s_add_u32 s52, s52, 32768
    v_and_b32 v11, 3, v1
    v_lshlrev_b32 v11, 2, v11
    buffer_load_dword v183, v11, s[4:7], s52 offen sc1
    buffer_load_dwordx4 v[160:163], v2, s[4:7], s51 offen offset:0 sc1
    buffer_load_dwordx4 v[164:167], v2, s[4:7], s51 offen offset:1024 sc1
    buffer_load_dwordx4 v[168:171], v2, s[4:7], s51 offen offset:2048 sc1
    buffer_load_dwordx4 v[172:175], v2, s[4:7], s51 offen offset:3072 sc1
    s_add_u32 s51, s51, 4096
    buffer_load_dwordx4 v[184:187], v2, s[4:7], s51 offen offset:0 sc1
    buffer_load_dwordx4 v[108:111], v2, s[4:7], s51 offen offset:1024 sc1
I2F_GO_194:
    s_waitcnt vmcnt(0)
    ds_write_b128 v13, v[160:163] offset:0
    ds_write_b128 v13, v[164:167] offset:1024
    ds_write_b128 v13, v[168:171] offset:2048
    ds_write_b128 v13, v[172:175] offset:3072
    ds_write_b128 v13, v[184:187] offset:4096
    ds_write_b128 v13, v[108:111] offset:5120
    v_mov_b32_dpp v15, v183 row_ror:2 row_mask:0xf bank_mask:0xf
    v_max_f32 v183, v183, v15
    s_nop 1
    v_mov_b32_dpp v15, v183 row_ror:1 row_mask:0xf bank_mask:0xf
    v_max_f32 v183, v183, v15
    v_mov_b32 v12, 51236
    s_mov_b64 exec, 1
    ds_write_b32 v12, v183
    s_mov_b64 exec, -1
    s_branch I2F_E_193
I2F_FILL_192:
    v_mov_b32 v160, 0
    v_mov_b32 v161, 0
    v_mov_b32 v162, 0
    v_mov_b32 v163, 0
    v_add_u32 v11, 0, v1
    v_mul_u32_u24 v12, 21846, v11
    v_lshrrev_b32 v12, 16, v12
    v_mul_u32_u24 v12, 3, v12
    v_sub_u32 v12, v11, v12
    v_cmp_eq_u32 vcc, 2, v12
    s_cmp_eq_u32 s38, 6
    s_cselect_b32 s55, 0xf14a, 0
    v_mov_b32 v14, s55
    v_cndmask_b32 v162, v160, v14, vcc
    ds_write_b128 v13, v[160:163] offset:0
    v_add_u32 v11, 64, v1
    v_mul_u32_u24 v12, 21846, v11
    v_lshrrev_b32 v12, 16, v12
    v_mul_u32_u24 v12, 3, v12
    v_sub_u32 v12, v11, v12
    v_cmp_eq_u32 vcc, 2, v12
    s_cmp_eq_u32 s38, 6
    s_cselect_b32 s55, 0xf14a, 0
    v_mov_b32 v14, s55
    v_cndmask_b32 v162, v160, v14, vcc
    ds_write_b128 v13, v[160:163] offset:1024
    v_add_u32 v11, 128, v1
    v_mul_u32_u24 v12, 21846, v11
    v_lshrrev_b32 v12, 16, v12
    v_mul_u32_u24 v12, 3, v12
    v_sub_u32 v12, v11, v12
    v_cmp_eq_u32 vcc, 2, v12
    s_cmp_eq_u32 s38, 6
    s_cselect_b32 s55, 0xf14a, 0
    v_mov_b32 v14, s55
    v_cndmask_b32 v162, v160, v14, vcc
    ds_write_b128 v13, v[160:163] offset:2048
    v_add_u32 v11, 192, v1
    v_mul_u32_u24 v12, 21846, v11
    v_lshrrev_b32 v12, 16, v12
    v_mul_u32_u24 v12, 3, v12
    v_sub_u32 v12, v11, v12
    v_cmp_eq_u32 vcc, 2, v12
    s_cmp_eq_u32 s38, 6
    s_cselect_b32 s55, 0xf14a, 0
    v_mov_b32 v14, s55
    v_cndmask_b32 v162, v160, v14, vcc
    ds_write_b128 v13, v[160:163] offset:3072
    v_add_u32 v11, 256, v1
    v_mul_u32_u24 v12, 21846, v11
    v_lshrrev_b32 v12, 16, v12
    v_mul_u32_u24 v12, 3, v12
    v_sub_u32 v12, v11, v12
    v_cmp_eq_u32 vcc, 2, v12
    s_cmp_eq_u32 s38, 6
    s_cselect_b32 s55, 0xf14a, 0
    v_mov_b32 v14, s55
    v_cndmask_b32 v162, v160, v14, vcc
    ds_write_b128 v13, v[160:163] offset:4096
    v_add_u32 v11, 320, v1
    v_mul_u32_u24 v12, 21846, v11
    v_lshrrev_b32 v12, 16, v12
    v_mul_u32_u24 v12, 3, v12
    v_sub_u32 v12, v11, v12
    v_cmp_eq_u32 vcc, 2, v12
    s_cmp_eq_u32 s38, 6
    s_cselect_b32 s55, 0xf14a, 0
    v_mov_b32 v14, s55
    v_cndmask_b32 v162, v160, v14, vcc
    ds_write_b128 v13, v[160:163] offset:5120
I2F_E_193:
    s_waitcnt lgkmcnt(0)
    v_mov_b32 v11, 52236
    v_mov_b32 v12, 1
    s_mov_b64 exec, 1
    ds_add_u32 v11, v12
    s_mov_b64 exec, -1
    s_waitcnt lgkmcnt(0)
    s_nop 4
    s_setpc_b64 s[88:89]
L_CODE_END:
.section .rodata,"a"
.p2align 6
.amdhsa_kernel interleave_layers__linear_attn_block__sliding_block__prompt_kernel
  .amdhsa_next_free_vgpr 256
  .amdhsa_next_free_sgpr 102
  .amdhsa_accum_offset 256
  .amdhsa_group_segment_fixed_size 0
  .amdhsa_kernarg_size 72
  .amdhsa_user_sgpr_count 2
  .amdhsa_user_sgpr_kernarg_segment_ptr 1
  .amdhsa_system_sgpr_workgroup_id_x 1
  .amdhsa_float_denorm_mode_32 3
  .amdhsa_float_denorm_mode_16_64 3
.end_amdhsa_kernel
```
